```python
import torch

def _softmax(x, axis=-1):
    return torch.softmax(x, dim=axis)

def _gelu(x):
    return torch.nn.functional.gelu(x, approximate='tanh')

def _silu(x):
    return torch.nn.functional.silu(x)

def _sigmoid(x):
    return torch.sigmoid(x)

def _layernorm(x, axis=-1, eps=1e-05):
    m = x.mean(dim=axis, keepdim=True)
    v = x.var(dim=axis, keepdim=True, unbiased=False)
    return (x - m) / torch.sqrt(v + eps)

def _scatter_add(tgt, idx, src, axis=0):
    return tgt.clone().index_add_(axis, idx, src)

def _segment_sum(src, seg, n):
    out = torch.zeros((n,) + src.shape[1:], dtype=src.dtype)
    return out.index_add_(0, seg, src)

def _pad(x, pw):
    flat = tuple((v for pair in reversed(pw) for v in pair))
    return torch.nn.functional.pad(x, flat)
kernel_name = 'adaLN_cond__ssm_conv_s4__glu_gated_swiglu__prompt'

def setup_inputs():

    _w = lambda a: (lambda t: t.to(torch.bfloat16) if t.is_floating_point() else t)(torch.as_tensor(a))

    def _A_setup():
        B, L, D, N = (1, 2048, 512, 128)
        A_re = -(lambda _x: torch.exp(torch.as_tensor(_x)))((lambda *s: torch.randn(*s, dtype=torch.bfloat16) * 3.2)(D, N))
        A_im = torch.pi * (lambda *s: torch.randn(*s, dtype=torch.bfloat16) * 0.05)(D, N)
        B_re = (lambda *s: torch.randn(*s, dtype=torch.bfloat16) * 0.1)(D, N)
        B_im = (lambda *s: torch.randn(*s, dtype=torch.bfloat16) * 0.1)(D, N)
        C_re = (lambda *s: torch.randn(*s, dtype=torch.bfloat16) * 0.1)(D, N)
        C_im = (lambda *s: torch.randn(*s, dtype=torch.bfloat16) * 0.1)(D, N)
        log_dt = (lambda *s: torch.randn(*s, dtype=torch.bfloat16) * 0.05)(D) * 0.5 - 4.0
        Dskip = (lambda *s: torch.randn(*s, dtype=torch.bfloat16) * 0.05)(D)
        return {'u': _w((lambda *s: torch.randn(*s, dtype=torch.bfloat16) * 0.05)(B, L, D)), 'A_re': _w(A_re), 'A_im': _w(A_im), 'B_re': _w(B_re), 'B_im': _w(B_im), 'C_re': _w(C_re), 'C_im': _w(C_im), 'log_dt': _w(log_dt), 'Dskip': _w(Dskip)}
    _A_in = _A_setup()

    def _B_setup():
        B, S, D, F = (1, 2048, 512, 1792)
        return {'x': _w((lambda *s: torch.randn(*s, dtype=torch.bfloat16) * 0.05)(B, S, D)), 'w1': _w((lambda *s: torch.randn(*s, dtype=torch.bfloat16) * 0.4)(D, F) * (2.0 / D) ** 0.5), 'w3': _w((lambda *s: torch.randn(*s, dtype=torch.bfloat16) * 0.4)(D, F) * (2.0 / D) ** 0.5), 'w2': _w((lambda *s: torch.randn(*s, dtype=torch.bfloat16) * 0.4)(F, D) * (2.0 / F) ** 0.5)}
    _B_in = _B_setup()
    return {'A_u': _A_in['u'], 'A_A_re': _A_in['A_re'], 'A_A_im': _A_in['A_im'], 'A_B_re': _A_in['B_re'], 'A_B_im': _A_in['B_im'], 'A_C_re': _A_in['C_re'], 'A_C_im': _A_in['C_im'], 'A_log_dt': _A_in['log_dt'], 'A_Dskip': _A_in['Dskip'], 'B_x': _B_in['x'], 'B_w1': _B_in['w1'], 'B_w3': _B_in['w3'], 'B_w2': _B_in['w2'], 'c': _w((lambda *s: torch.randn(*s, dtype=torch.bfloat16) * 0.2)(1, 512) * 8.0), 'w_mod': _w((lambda *s: torch.randn(*s, dtype=torch.bfloat16) * 0.2)(512, 6 * 512) * 512 ** (-0.5) * 8.0)}

def reference(A_u, A_A_re, A_A_im, A_B_re, A_B_im, A_C_re, A_C_im, A_log_dt, A_Dskip, B_x, B_w1, B_w3, B_w2, c, w_mod):

    def _A_ref(u, A_re, A_im, B_re, B_im, C_re, C_im, log_dt, Dskip):
        Bsz, L, D = u.shape
        dt = torch.exp(log_dt)[:, None]
        A = A_re + 1j * A_im
        Bc = B_re + 1j * B_im
        Cc = C_re + 1j * C_im
        logdA = dt * A
        dB = dt * Bc
        l = (lambda x, dt: x.to(dt))(torch.arange(L), A_re.dtype)
        P = torch.exp(logdA[:, :, None] * l[None, None, :])
        K = torch.einsum('dn,dnl,dn->dl', Cc, P, dB).real
        L2 = 2 * L
        Kp = _pad(K, ((0, 0), (0, L)))
        up = (lambda x, *d: x.permute(*d))(u, 0, 2, 1)
        up = _pad(up, ((0, 0), (0, 0), (0, L)))
        Kf = (lambda x, axes=(-2, -1): torch.fft.rfft2(x.float(), dim=axes))(Kp[:, None, :], axes=(-2, -1))
        Uf = (lambda x, axes=(-2, -1): torch.fft.rfft2(x.float(), dim=axes))(up[:, :, None, :], axes=(-2, -1))
        Yf = Uf * Kf[None, :, :, :]
        y = (lambda x, s, axes=(-2, -1): torch.fft.irfft2(x, s=s, dim=axes).to(torch.bfloat16))(Yf, (1, L2), axes=(-2, -1))[:, :, 0, :L]
        y = (lambda x, *d: x.permute(*d))(y, 0, 2, 1) + u * Dskip[None, None, :]
        return y

    def _B_ref(x, w1, w3, w2):
        gate = torch.einsum('bsd,df->bsf', x, w1)
        up = torch.einsum('bsd,df->bsf', x, w3)
        h = _silu(gate) * up
        out = torch.einsum('bsf,fd->bsd', h, w2)
        return out
    x = A_u
    mod = (_silu(c) @ w_mod).reshape(c.shape[0], 6, 1, -1)
    sa, ca, ga, sb, cb, gb = (mod[:, 0].clone(), mod[:, 1].clone(), mod[:, 2].clone(), mod[:, 3].clone(), mod[:, 4].clone(), mod[:, 5].clone())
    h = _layernorm(x, axis=-1) * (1 + ca) + sa
    x = x + ga * _A_ref(h, A_A_re, A_A_im, A_B_re, A_B_im, A_C_re, A_C_im, A_log_dt, A_Dskip)
    h = _layernorm(x, axis=-1) * (1 + cb) + sb
    x = x + gb * _B_ref(h, B_w1, B_w3, B_w2)
    return x
```

```asm
; @launch grid=(256,1,1) block=(512,1,1) lds=163840
.amdgcn_target "amdgcn-amd-amdhsa--gfx950"
.text
.globl adaLN_cond__ssm_conv_s4__glu_gated_swiglu__prompt_kernel
.p2align 8
.type adaLN_cond__ssm_conv_s4__glu_gated_swiglu__prompt_kernel,@function
adaLN_cond__ssm_conv_s4__glu_gated_swiglu__prompt_kernel:
  s_cmp_ge_u32 s2, 256
  s_cbranch_scc1 F_END
  s_load_dwordx16 s[8:23], s[0:1], 8
  s_load_dwordx4 s[4:7], s[0:1], 128
  s_load_dwordx4 s[24:27], s[0:1], 80
  s_load_dwordx2 s[58:59], s[0:1], 112
  s_load_dwordx2 s[64:65], s[0:1], 0
  s_load_dwordx4 s[68:71], s[0:1], 96
  s_load_dwordx2 s[72:73], s[0:1], 120
  v_lshrrev_b32 v2, 6, v0
  v_and_b32 v1, 63, v0
  s_nop 0
  v_readfirstlane_b32 s3, v2
  v_and_b32 v3, 255, v0
  s_lshl_b32 s28, s2, 9
  v_lshl_add_u32 v4, v3, 1, s28
  s_lshl_b32 s28, s2, 1
  v_lshrrev_b32 v5, 7, v3
  v_add_u32 v5, s28, v5
  v_lshlrev_b32 v5, 1, v5
  v_mov_b32 v6, 163808
  v_mov_b32 v8, 0
  v_mov_b32 v9, 0
  ds_write_b64 v6, v[8:9]
  ds_write_b64 v6, v[8:9] offset:8
  ds_write_b64 v6, v[8:9] offset:16
  s_waitcnt lgkmcnt(0)
  s_mov_b32 s28, s4
  s_mov_b32 s29, s5
  s_mov_b32 s4, s6
  s_mov_b32 s5, s7
  s_mov_b32 s6, s28
  s_mov_b32 s7, s29
  s_mov_b32 s36, s4
  s_mov_b32 s37, s5
  s_mov_b32 s38, 0x1340000
  s_mov_b32 s39, 0x00020000
  s_and_b32 s28, s2, 7
  s_lshr_b32 s29, s2, 3
  s_lshr_b32 s48, s28, 2
  s_lshl_b32 s48, s48, 3
  s_lshr_b32 s30, s29, 2
  s_add_u32 s48, s48, s30
  s_and_b32 s49, s28, 3
  s_lshl_b32 s49, s49, 2
  s_and_b32 s30, s29, 3
  s_add_u32 s49, s49, s30
  s_lshl_b32 s46, s48, 4
  s_add_u32 s46, s46, s49
  s_lshl_b32 s46, s46, 3
  s_or_b32 s28, s2, s3
  s_cmp_lg_u32 s28, 0
  s_cbranch_scc1 P_NT
  s_memrealtime s[40:41]
  s_waitcnt lgkmcnt(0)
  s_or_b32 s40, s40, 1
  v_lshlrev_b32 v176, 3, v1
  v_mov_b32 v178, s40
  v_mov_b32 v179, s41
  s_mov_b32 exec_hi, 0
  global_store_dwordx2 v176, v[178:179], s[6:7] sc1
  s_mov_b64 exec, -1
P_NT:
  s_and_b32 s35, s2, 31
  s_lshl_b32 s35, s35, 3
  v_mov_b32 v176, 0x132f000
  global_load_dword v177, v176, s[4:5]
  s_cmp_ge_u32 s3, 4
  s_cbranch_scc1 P_NL
  global_load_ushort v120, v4, s[8:9]
  global_load_ushort v121, v4, s[10:11]
  global_load_ushort v122, v4, s[12:13]
  global_load_ushort v123, v4, s[14:15]
  global_load_ushort v124, v4, s[16:17]
  global_load_ushort v125, v4, s[18:19]
  global_load_ushort v126, v5, s[20:21]
P_NL:
  s_lshr_b32 s28, s3, 2
  s_lshl_b32 s29, s2, 1
  s_add_u32 s29, s29, s28
  s_lshl_b32 s29, s29, 1
  v_mov_b32 v5, s29
  global_load_ushort v127, v5, s[22:23]
  s_and_b32 s30, s2, 7
  s_mul_i32 s30, s30, 28
  s_lshr_b32 s31, s2, 3
  s_min_u32 s31, s31, 27
  s_add_u32 s30, s30, s31
  s_cmp_ge_u32 s30, 112
  s_cselect_b32 s32, 1, 0
  s_cselect_b32 s56, s26, s24
  s_cselect_b32 s57, s27, s25
  s_mul_i32 s33, s32, 112
  s_sub_u32 s33, s30, s33
  s_cmp_ge_u32 s3, 4
  s_cbranch_scc1 P_NP
  s_lshr_b32 s28, s2, 3
  s_lshl_b32 s28, s28, 2
  s_add_u32 s28, s28, s3
  s_mul_i32 s28, s28, 24576
  s_and_b32 s29, s2, 7
  s_mul_i32 s29, s29, 768
  s_add_u32 s28, s28, s29
  v_min_u32 v6, 47, v1
  v_lshl_add_u32 v6, v6, 4, s28
  global_load_dwordx4 v[128:131], v6, s[58:59]
  v_add_u32 v6, 6144, v6
  global_load_dwordx4 v[132:135], v6, s[58:59]
  v_add_u32 v6, 6144, v6
  global_load_dwordx4 v[136:139], v6, s[58:59]
  v_add_u32 v6, 6144, v6
  global_load_dwordx4 v[140:143], v6, s[58:59]
  v_add_u32 v6, 6144, v6
P_NP:
  s_mov_b32 s20, 0x05040100
  s_mov_b32 s21, 0x07060302
  s_mov_b32 s22, 0x3f803f80
  s_barrier
  s_cmp_lt_u32 s3, 4
  s_cbranch_scc1 R_END
  s_and_b32 s26, s2, 3
  v_mov_b32 v2, s26
  s_lshr_b32 s31, s2, 2
  s_cmp_eq_u32 s3, 7
  s_cbranch_scc1 R_W2
  s_cmp_eq_u32 s3, 5
  s_cbranch_scc1 R_S
  s_cmp_eq_u32 s3, 6
  s_cbranch_scc1 R_MOD
  s_mov_b64 s[24:25], s[64:65]
  v_and_b32 v7, 3, v1
  v_lshrrev_b32 v8, 2, v1
  v_lshl_add_u32 v8, v2, 4, v8
  s_lshl_b32 s26, s31, 5
  v_lshl_add_u32 v3, v7, 3, s26
  v_lshlrev_b32 v4, 10, v3
  v_lshl_add_u32 v4, v8, 4, v4
  v_add_u32 v5, 0x1000, v4
  global_load_dwordx4 v[16:19], v4, s[24:25] offset:0
  global_load_dwordx4 v[20:23], v4, s[24:25] offset:1024
  global_load_dwordx4 v[24:27], v4, s[24:25] offset:2048
  global_load_dwordx4 v[28:31], v4, s[24:25] offset:3072
  global_load_dwordx4 v[32:35], v5, s[24:25] offset:0
  global_load_dwordx4 v[36:39], v5, s[24:25] offset:1024
  global_load_dwordx4 v[40:43], v5, s[24:25] offset:2048
  global_load_dwordx4 v[44:47], v5, s[24:25] offset:3072
  v_lshlrev_b32 v6, 15, v8
  v_lshl_add_u32 v6, v3, 1, v6
  s_waitcnt vmcnt(0)
  v_perm_b32 v48, v20, v16, s20
  v_perm_b32 v49, v28, v24, s20
  v_perm_b32 v50, v36, v32, s20
  v_perm_b32 v51, v44, v40, s20
  v_perm_b32 v52, v20, v16, s21
  v_perm_b32 v53, v28, v24, s21
  v_perm_b32 v54, v36, v32, s21
  v_perm_b32 v55, v44, v40, s21
  v_perm_b32 v56, v21, v17, s20
  v_perm_b32 v57, v29, v25, s20
  v_perm_b32 v58, v37, v33, s20
  v_perm_b32 v59, v45, v41, s20
  v_perm_b32 v60, v21, v17, s21
  v_perm_b32 v61, v29, v25, s21
  v_perm_b32 v62, v37, v33, s21
  v_perm_b32 v63, v45, v41, s21
  v_perm_b32 v64, v22, v18, s20
  v_perm_b32 v65, v30, v26, s20
  v_perm_b32 v66, v38, v34, s20
  v_perm_b32 v67, v46, v42, s20
  v_perm_b32 v68, v22, v18, s21
  v_perm_b32 v69, v30, v26, s21
  v_perm_b32 v70, v38, v34, s21
  v_perm_b32 v71, v46, v42, s21
  v_perm_b32 v72, v23, v19, s20
  v_perm_b32 v73, v31, v27, s20
  v_perm_b32 v74, v39, v35, s20
  v_perm_b32 v75, v47, v43, s20
  v_perm_b32 v76, v23, v19, s21
  v_perm_b32 v77, v31, v27, s21
  v_perm_b32 v78, v39, v35, s21
  v_perm_b32 v79, v47, v43, s21
  s_mov_b32 s26, 0
  buffer_store_dwordx4 v[48:51], v6, s[36:39], s26 offen sc1
  s_mov_b32 s26, 4096
  buffer_store_dwordx4 v[52:55], v6, s[36:39], s26 offen sc1
  s_mov_b32 s26, 8192
  buffer_store_dwordx4 v[56:59], v6, s[36:39], s26 offen sc1
  s_mov_b32 s26, 12288
  buffer_store_dwordx4 v[60:63], v6, s[36:39], s26 offen sc1
  s_mov_b32 s26, 16384
  buffer_store_dwordx4 v[64:67], v6, s[36:39], s26 offen sc1
  s_mov_b32 s26, 20480
  buffer_store_dwordx4 v[68:71], v6, s[36:39], s26 offen sc1
  s_mov_b32 s26, 24576
  buffer_store_dwordx4 v[72:75], v6, s[36:39], s26 offen sc1
  s_mov_b32 s26, 28672
  buffer_store_dwordx4 v[76:79], v6, s[36:39], s26 offen sc1
  s_branch R_SIG
R_S:
  s_mov_b64 s[24:25], s[64:65]
  s_lshl_b32 s26, s31, 5
  v_lshl_add_u32 v3, v2, 3, s26
  v_lshlrev_b32 v4, 10, v3
  v_lshl_add_u32 v4, v1, 4, v4
  v_add_u32 v5, 0x1000, v4
  global_load_dwordx4 v[16:19], v4, s[24:25] offset:0
  global_load_dwordx4 v[20:23], v4, s[24:25] offset:1024
  global_load_dwordx4 v[24:27], v4, s[24:25] offset:2048
  global_load_dwordx4 v[28:31], v4, s[24:25] offset:3072
  global_load_dwordx4 v[32:35], v5, s[24:25] offset:0
  global_load_dwordx4 v[36:39], v5, s[24:25] offset:1024
  global_load_dwordx4 v[40:43], v5, s[24:25] offset:2048
  global_load_dwordx4 v[44:47], v5, s[24:25] offset:3072
  v_mov_b32 v80, 0
  v_mov_b32 v81, 0
  v_mov_b32 v82, 0
  v_mov_b32 v83, 0
  v_mov_b32 v84, 0
  v_mov_b32 v85, 0
  v_mov_b32 v86, 0
  v_mov_b32 v87, 0
  v_mov_b32 v88, 0
  v_mov_b32 v89, 0
  v_mov_b32 v90, 0
  v_mov_b32 v91, 0
  v_mov_b32 v92, 0
  v_mov_b32 v93, 0
  v_mov_b32 v94, 0
  v_mov_b32 v95, 0
  s_waitcnt vmcnt(7)
  v_dot2_f32_bf16 v80, v16, s22, v80
  v_dot2_f32_bf16 v88, v16, v16, v88
  v_dot2_f32_bf16 v80, v17, s22, v80
  v_dot2_f32_bf16 v88, v17, v17, v88
  v_dot2_f32_bf16 v80, v18, s22, v80
  v_dot2_f32_bf16 v88, v18, v18, v88
  v_dot2_f32_bf16 v80, v19, s22, v80
  v_dot2_f32_bf16 v88, v19, v19, v88
  s_waitcnt vmcnt(6)
  v_dot2_f32_bf16 v81, v20, s22, v81
  v_dot2_f32_bf16 v89, v20, v20, v89
  v_dot2_f32_bf16 v81, v21, s22, v81
  v_dot2_f32_bf16 v89, v21, v21, v89
  v_dot2_f32_bf16 v81, v22, s22, v81
  v_dot2_f32_bf16 v89, v22, v22, v89
  v_dot2_f32_bf16 v81, v23, s22, v81
  v_dot2_f32_bf16 v89, v23, v23, v89
  s_waitcnt vmcnt(5)
  v_dot2_f32_bf16 v82, v24, s22, v82
  v_dot2_f32_bf16 v90, v24, v24, v90
  v_dot2_f32_bf16 v82, v25, s22, v82
  v_dot2_f32_bf16 v90, v25, v25, v90
  v_dot2_f32_bf16 v82, v26, s22, v82
  v_dot2_f32_bf16 v90, v26, v26, v90
  v_dot2_f32_bf16 v82, v27, s22, v82
  v_dot2_f32_bf16 v90, v27, v27, v90
  s_waitcnt vmcnt(4)
  v_dot2_f32_bf16 v83, v28, s22, v83
  v_dot2_f32_bf16 v91, v28, v28, v91
  v_dot2_f32_bf16 v83, v29, s22, v83
  v_dot2_f32_bf16 v91, v29, v29, v91
  v_dot2_f32_bf16 v83, v30, s22, v83
  v_dot2_f32_bf16 v91, v30, v30, v91
  v_dot2_f32_bf16 v83, v31, s22, v83
  v_dot2_f32_bf16 v91, v31, v31, v91
  s_waitcnt vmcnt(3)
  v_dot2_f32_bf16 v84, v32, s22, v84
  v_dot2_f32_bf16 v92, v32, v32, v92
  v_dot2_f32_bf16 v84, v33, s22, v84
  v_dot2_f32_bf16 v92, v33, v33, v92
  v_dot2_f32_bf16 v84, v34, s22, v84
  v_dot2_f32_bf16 v92, v34, v34, v92
  v_dot2_f32_bf16 v84, v35, s22, v84
  v_dot2_f32_bf16 v92, v35, v35, v92
  s_waitcnt vmcnt(2)
  v_dot2_f32_bf16 v85, v36, s22, v85
  v_dot2_f32_bf16 v93, v36, v36, v93
  v_dot2_f32_bf16 v85, v37, s22, v85
  v_dot2_f32_bf16 v93, v37, v37, v93
  v_dot2_f32_bf16 v85, v38, s22, v85
  v_dot2_f32_bf16 v93, v38, v38, v93
  v_dot2_f32_bf16 v85, v39, s22, v85
  v_dot2_f32_bf16 v93, v39, v39, v93
  s_waitcnt vmcnt(1)
  v_dot2_f32_bf16 v86, v40, s22, v86
  v_dot2_f32_bf16 v94, v40, v40, v94
  v_dot2_f32_bf16 v86, v41, s22, v86
  v_dot2_f32_bf16 v94, v41, v41, v94
  v_dot2_f32_bf16 v86, v42, s22, v86
  v_dot2_f32_bf16 v94, v42, v42, v94
  v_dot2_f32_bf16 v86, v43, s22, v86
  v_dot2_f32_bf16 v94, v43, v43, v94
  s_waitcnt vmcnt(0)
  v_dot2_f32_bf16 v87, v44, s22, v87
  v_dot2_f32_bf16 v95, v44, v44, v95
  v_dot2_f32_bf16 v87, v45, s22, v87
  v_dot2_f32_bf16 v95, v45, v45, v95
  v_dot2_f32_bf16 v87, v46, s22, v87
  v_dot2_f32_bf16 v95, v46, v46, v95
  v_dot2_f32_bf16 v87, v47, s22, v87
  v_dot2_f32_bf16 v95, v47, v47, v95
  v_permlane32_swap_b32 v80, v84
  v_permlane32_swap_b32 v81, v85
  v_permlane32_swap_b32 v82, v86
  v_permlane32_swap_b32 v83, v87
  v_add_f32 v80, v80, v84
  v_add_f32 v81, v81, v85
  v_add_f32 v82, v82, v86
  v_add_f32 v83, v83, v87
  s_nop 0
  v_permlane16_swap_b32 v80, v82
  v_permlane16_swap_b32 v81, v83
  v_add_f32 v80, v80, v82
  v_add_f32 v81, v81, v83
  v_permlane32_swap_b32 v88, v92
  v_permlane32_swap_b32 v89, v93
  v_permlane32_swap_b32 v90, v94
  v_permlane32_swap_b32 v91, v95
  v_add_f32 v88, v88, v92
  v_add_f32 v89, v89, v93
  v_add_f32 v90, v90, v94
  v_add_f32 v91, v91, v95
  s_nop 0
  v_permlane16_swap_b32 v88, v90
  v_permlane16_swap_b32 v89, v91
  v_add_f32 v88, v88, v90
  v_add_f32 v89, v89, v91
  v_add_f32_dpp v80, v80, v80 quad_perm:[1,0,3,2] row_mask:0xf bank_mask:0xf
  v_add_f32_dpp v81, v81, v81 quad_perm:[1,0,3,2] row_mask:0xf bank_mask:0xf
  v_add_f32_dpp v88, v88, v88 quad_perm:[1,0,3,2] row_mask:0xf bank_mask:0xf
  v_add_f32_dpp v89, v89, v89 quad_perm:[1,0,3,2] row_mask:0xf bank_mask:0xf
  v_add_f32_dpp v80, v80, v80 quad_perm:[2,3,0,1] row_mask:0xf bank_mask:0xf
  v_add_f32_dpp v81, v81, v81 quad_perm:[2,3,0,1] row_mask:0xf bank_mask:0xf
  v_add_f32_dpp v88, v88, v88 quad_perm:[2,3,0,1] row_mask:0xf bank_mask:0xf
  v_add_f32_dpp v89, v89, v89 quad_perm:[2,3,0,1] row_mask:0xf bank_mask:0xf
  v_add_f32_dpp v80, v80, v80 row_half_mirror row_mask:0xf bank_mask:0xf
  v_add_f32_dpp v81, v81, v81 row_half_mirror row_mask:0xf bank_mask:0xf
  v_add_f32_dpp v88, v88, v88 row_half_mirror row_mask:0xf bank_mask:0xf
  v_add_f32_dpp v89, v89, v89 row_half_mirror row_mask:0xf bank_mask:0xf
  v_add_f32_dpp v80, v80, v80 row_mirror row_mask:0xf bank_mask:0xf
  v_add_f32_dpp v81, v81, v81 row_mirror row_mask:0xf bank_mask:0xf
  v_add_f32_dpp v88, v88, v88 row_mirror row_mask:0xf bank_mask:0xf
  v_add_f32_dpp v89, v89, v89 row_mirror row_mask:0xf bank_mask:0xf
  v_mul_f32 v96, 0x3b000000, v80
  v_mul_f32 v100, 0x3b000000, v88
  v_fma_f32 v100, -v96, v96, v100
  v_max_f32 v100, 0, v100
  v_cvt_pk_bf16_f32 v100, v100, v100
  v_lshlrev_b32 v100, 16, v100
  v_add_f32 v100, 0x3727c5ac, v100
  v_cvt_pk_bf16_f32 v100, v100, v100
  v_lshlrev_b32 v100, 16, v100
  v_sqrt_f32 v100, v100
  s_nop 0
  v_cvt_pk_bf16_f32 v100, v100, v100
  v_lshlrev_b32 v100, 16, v100
  v_rcp_f32 v97, v100
  v_cvt_pk_bf16_f32 v96, v96, v96
  v_lshlrev_b32 v96, 16, v96
  v_mul_f32 v98, 0x3b000000, v81
  v_mul_f32 v101, 0x3b000000, v89
  v_fma_f32 v101, -v98, v98, v101
  v_max_f32 v101, 0, v101
  v_cvt_pk_bf16_f32 v101, v101, v101
  v_lshlrev_b32 v101, 16, v101
  v_add_f32 v101, 0x3727c5ac, v101
  v_cvt_pk_bf16_f32 v101, v101, v101
  v_lshlrev_b32 v101, 16, v101
  v_sqrt_f32 v101, v101
  s_nop 0
  v_cvt_pk_bf16_f32 v101, v101, v101
  v_lshlrev_b32 v101, 16, v101
  v_rcp_f32 v99, v101
  v_cvt_pk_bf16_f32 v98, v98, v98
  v_lshlrev_b32 v98, 16, v98
  v_lshrrev_b32 v7, 4, v1
  v_lshl_add_u32 v7, v7, 1, v3
  v_lshlrev_b32 v7, 3, v7
  s_mov_b32 s26, 0x1300000
  v_and_b32 v8, 15, v1
  v_cmp_eq_u32 vcc, 0, v8
  s_and_saveexec_b64 s[44:45], vcc
  buffer_store_dwordx4 v[96:99], v7, s[36:39], s26 offen sc1
  s_mov_b64 exec, s[44:45]
  s_branch R_SIG
R_MOD:
  s_cmp_ge_u32 s2, 192
  s_cbranch_scc1 R_SIG
  s_mov_b64 s[24:25], s[58:59]
  s_mov_b64 s[26:27], s[70:71]
  s_and_b32 s28, s2, 7
  s_mul_i32 s28, s28, 24
  s_lshr_b32 s29, s2, 3
  s_add_u32 s28, s28, s29
  v_lshrrev_b32 v3, 1, v1
  v_and_b32 v4, 1, v1
  v_lshlrev_b32 v5, 4, v1
  global_load_dwordx4 v[8:11], v5, s[26:27]
  v_mul_u32_u24 v5, 6144, v3
  v_lshl_add_u32 v5, v4, 4, v5
  s_lshl_b32 s29, s28, 5
  v_add_u32 v5, s29, v5
  v_lshlrev_b32 v6, 5, v1
  v_add_u32 v6, 155648, v6
  v_lshlrev_b32 v7, 2, v3
  v_add_u32 v7, 155648, v7
  s_waitcnt vmcnt(0)
  v_lshlrev_b32 v16, 16, v8
  v_and_b32 v17, 0xffff0000, v8
  v_lshlrev_b32 v18, 16, v9
  v_and_b32 v19, 0xffff0000, v9
  v_lshlrev_b32 v20, 16, v10
  v_and_b32 v21, 0xffff0000, v10
  v_lshlrev_b32 v22, 16, v11
  v_and_b32 v23, 0xffff0000, v11
  v_mul_f32 v100, 0xbfb8aa3b, v16
  v_exp_f32 v100, v100
  s_nop 0
  v_add_f32 v100, 1.0, v100
  v_rcp_f32 v100, v100
  s_nop 0
  v_mul_f32 v16, v16, v100
  v_cvt_pk_bf16_f32 v16, v16, v16
  v_lshlrev_b32 v16, 16, v16
  v_mul_f32 v100, 0xbfb8aa3b, v17
  v_exp_f32 v100, v100
  s_nop 0
  v_add_f32 v100, 1.0, v100
  v_rcp_f32 v100, v100
  s_nop 0
  v_mul_f32 v17, v17, v100
  v_cvt_pk_bf16_f32 v17, v17, v17
  v_lshlrev_b32 v17, 16, v17
  v_mul_f32 v100, 0xbfb8aa3b, v18
  v_exp_f32 v100, v100
  s_nop 0
  v_add_f32 v100, 1.0, v100
  v_rcp_f32 v100, v100
  s_nop 0
  v_mul_f32 v18, v18, v100
  v_cvt_pk_bf16_f32 v18, v18, v18
  v_lshlrev_b32 v18, 16, v18
  v_mul_f32 v100, 0xbfb8aa3b, v19
  v_exp_f32 v100, v100
  s_nop 0
  v_add_f32 v100, 1.0, v100
  v_rcp_f32 v100, v100
  s_nop 0
  v_mul_f32 v19, v19, v100
  v_cvt_pk_bf16_f32 v19, v19, v19
  v_lshlrev_b32 v19, 16, v19
  v_mul_f32 v100, 0xbfb8aa3b, v20
  v_exp_f32 v100, v100
  s_nop 0
  v_add_f32 v100, 1.0, v100
  v_rcp_f32 v100, v100
  s_nop 0
  v_mul_f32 v20, v20, v100
  v_cvt_pk_bf16_f32 v20, v20, v20
  v_lshlrev_b32 v20, 16, v20
  v_mul_f32 v100, 0xbfb8aa3b, v21
  v_exp_f32 v100, v100
  s_nop 0
  v_add_f32 v100, 1.0, v100
  v_rcp_f32 v100, v100
  s_nop 0
  v_mul_f32 v21, v21, v100
  v_cvt_pk_bf16_f32 v21, v21, v21
  v_lshlrev_b32 v21, 16, v21
  v_mul_f32 v100, 0xbfb8aa3b, v22
  v_exp_f32 v100, v100
  s_nop 0
  v_add_f32 v100, 1.0, v100
  v_rcp_f32 v100, v100
  s_nop 0
  v_mul_f32 v22, v22, v100
  v_cvt_pk_bf16_f32 v22, v22, v22
  v_lshlrev_b32 v22, 16, v22
  v_mul_f32 v100, 0xbfb8aa3b, v23
  v_exp_f32 v100, v100
  s_nop 0
  v_add_f32 v100, 1.0, v100
  v_rcp_f32 v100, v100
  s_nop 0
  v_mul_f32 v23, v23, v100
  v_cvt_pk_bf16_f32 v23, v23, v23
  v_lshlrev_b32 v23, 16, v23
  ds_write_b128 v6, v[16:19]
  ds_write_b128 v6, v[20:23] offset:16
  s_waitcnt lgkmcnt(0)
  global_load_dwordx4 v[32:35], v5, s[24:25]
  v_add_u32 v5, 0x30000, v5
  global_load_dwordx4 v[36:39], v5, s[24:25]
  v_add_u32 v5, 0x30000, v5
  global_load_dwordx4 v[40:43], v5, s[24:25]
  v_add_u32 v5, 0x30000, v5
  global_load_dwordx4 v[44:47], v5, s[24:25]
  v_add_u32 v5, 0x30000, v5
  global_load_dwordx4 v[48:51], v5, s[24:25]
  v_add_u32 v5, 0x30000, v5
  global_load_dwordx4 v[52:55], v5, s[24:25]
  v_add_u32 v5, 0x30000, v5
  global_load_dwordx4 v[56:59], v5, s[24:25]
  v_add_u32 v5, 0x30000, v5
  global_load_dwordx4 v[60:63], v5, s[24:25]
  v_add_u32 v5, 0x30000, v5
  global_load_dwordx4 v[64:67], v5, s[24:25]
  v_add_u32 v5, 0x30000, v5
  global_load_dwordx4 v[68:71], v5, s[24:25]
  v_add_u32 v5, 0x30000, v5
  global_load_dwordx4 v[72:75], v5, s[24:25]
  v_add_u32 v5, 0x30000, v5
  global_load_dwordx4 v[76:79], v5, s[24:25]
  v_add_u32 v5, 0x30000, v5
  global_load_dwordx4 v[80:83], v5, s[24:25]
  v_add_u32 v5, 0x30000, v5
  global_load_dwordx4 v[84:87], v5, s[24:25]
  v_add_u32 v5, 0x30000, v5
  global_load_dwordx4 v[88:91], v5, s[24:25]
  v_add_u32 v5, 0x30000, v5
  global_load_dwordx4 v[92:95], v5, s[24:25]
  v_add_u32 v5, 0x30000, v5
  ds_read_b32 v16, v7 offset:0
  ds_read_b32 v17, v7 offset:128
  ds_read_b32 v18, v7 offset:256
  ds_read_b32 v19, v7 offset:384
  ds_read_b32 v20, v7 offset:512
  ds_read_b32 v21, v7 offset:640
  ds_read_b32 v22, v7 offset:768
  ds_read_b32 v23, v7 offset:896
  s_waitcnt lgkmcnt(0)
  ds_read_b32 v24, v7 offset:1024
  ds_read_b32 v25, v7 offset:1152
  ds_read_b32 v26, v7 offset:1280
  ds_read_b32 v27, v7 offset:1408
  ds_read_b32 v28, v7 offset:1536
  ds_read_b32 v29, v7 offset:1664
  ds_read_b32 v30, v7 offset:1792
  ds_read_b32 v31, v7 offset:1920
  s_waitcnt lgkmcnt(0)
  v_mov_b32 v104, 0
  v_mov_b32 v105, 0
  v_mov_b32 v106, 0
  v_mov_b32 v107, 0
  v_mov_b32 v108, 0
  v_mov_b32 v109, 0
  v_mov_b32 v110, 0
  v_mov_b32 v111, 0
  s_waitcnt vmcnt(15)
  v_lshlrev_b32 v100, 16, v32
  v_and_b32 v101, 0xffff0000, v32
  v_pk_fma_f32 v[104:105], v[100:101], v[16:17], v[104:105] op_sel:[0,0,0] op_sel_hi:[1,0,1]
  v_lshlrev_b32 v100, 16, v33
  v_and_b32 v101, 0xffff0000, v33
  v_pk_fma_f32 v[106:107], v[100:101], v[16:17], v[106:107] op_sel:[0,0,0] op_sel_hi:[1,0,1]
  v_lshlrev_b32 v100, 16, v34
  v_and_b32 v101, 0xffff0000, v34
  v_pk_fma_f32 v[108:109], v[100:101], v[16:17], v[108:109] op_sel:[0,0,0] op_sel_hi:[1,0,1]
  v_lshlrev_b32 v100, 16, v35
  v_and_b32 v101, 0xffff0000, v35
  v_pk_fma_f32 v[110:111], v[100:101], v[16:17], v[110:111] op_sel:[0,0,0] op_sel_hi:[1,0,1]
  s_waitcnt vmcnt(14)
  v_lshlrev_b32 v100, 16, v36
  v_and_b32 v101, 0xffff0000, v36
  v_pk_fma_f32 v[104:105], v[100:101], v[16:17], v[104:105] op_sel:[0,1,0] op_sel_hi:[1,1,1]
  v_lshlrev_b32 v100, 16, v37
  v_and_b32 v101, 0xffff0000, v37
  v_pk_fma_f32 v[106:107], v[100:101], v[16:17], v[106:107] op_sel:[0,1,0] op_sel_hi:[1,1,1]
  v_lshlrev_b32 v100, 16, v38
  v_and_b32 v101, 0xffff0000, v38
  v_pk_fma_f32 v[108:109], v[100:101], v[16:17], v[108:109] op_sel:[0,1,0] op_sel_hi:[1,1,1]
  v_lshlrev_b32 v100, 16, v39
  v_and_b32 v101, 0xffff0000, v39
  v_pk_fma_f32 v[110:111], v[100:101], v[16:17], v[110:111] op_sel:[0,1,0] op_sel_hi:[1,1,1]
  s_waitcnt vmcnt(13)
  v_lshlrev_b32 v100, 16, v40
  v_and_b32 v101, 0xffff0000, v40
  v_pk_fma_f32 v[104:105], v[100:101], v[18:19], v[104:105] op_sel:[0,0,0] op_sel_hi:[1,0,1]
  v_lshlrev_b32 v100, 16, v41
  v_and_b32 v101, 0xffff0000, v41
  v_pk_fma_f32 v[106:107], v[100:101], v[18:19], v[106:107] op_sel:[0,0,0] op_sel_hi:[1,0,1]
  v_lshlrev_b32 v100, 16, v42
  v_and_b32 v101, 0xffff0000, v42
  v_pk_fma_f32 v[108:109], v[100:101], v[18:19], v[108:109] op_sel:[0,0,0] op_sel_hi:[1,0,1]
  v_lshlrev_b32 v100, 16, v43
  v_and_b32 v101, 0xffff0000, v43
  v_pk_fma_f32 v[110:111], v[100:101], v[18:19], v[110:111] op_sel:[0,0,0] op_sel_hi:[1,0,1]
  s_waitcnt vmcnt(12)
  v_lshlrev_b32 v100, 16, v44
  v_and_b32 v101, 0xffff0000, v44
  v_pk_fma_f32 v[104:105], v[100:101], v[18:19], v[104:105] op_sel:[0,1,0] op_sel_hi:[1,1,1]
  v_lshlrev_b32 v100, 16, v45
  v_and_b32 v101, 0xffff0000, v45
  v_pk_fma_f32 v[106:107], v[100:101], v[18:19], v[106:107] op_sel:[0,1,0] op_sel_hi:[1,1,1]
  v_lshlrev_b32 v100, 16, v46
  v_and_b32 v101, 0xffff0000, v46
  v_pk_fma_f32 v[108:109], v[100:101], v[18:19], v[108:109] op_sel:[0,1,0] op_sel_hi:[1,1,1]
  v_lshlrev_b32 v100, 16, v47
  v_and_b32 v101, 0xffff0000, v47
  v_pk_fma_f32 v[110:111], v[100:101], v[18:19], v[110:111] op_sel:[0,1,0] op_sel_hi:[1,1,1]
  s_waitcnt vmcnt(11)
  v_lshlrev_b32 v100, 16, v48
  v_and_b32 v101, 0xffff0000, v48
  v_pk_fma_f32 v[104:105], v[100:101], v[20:21], v[104:105] op_sel:[0,0,0] op_sel_hi:[1,0,1]
  v_lshlrev_b32 v100, 16, v49
  v_and_b32 v101, 0xffff0000, v49
  v_pk_fma_f32 v[106:107], v[100:101], v[20:21], v[106:107] op_sel:[0,0,0] op_sel_hi:[1,0,1]
  v_lshlrev_b32 v100, 16, v50
  v_and_b32 v101, 0xffff0000, v50
  v_pk_fma_f32 v[108:109], v[100:101], v[20:21], v[108:109] op_sel:[0,0,0] op_sel_hi:[1,0,1]
  v_lshlrev_b32 v100, 16, v51
  v_and_b32 v101, 0xffff0000, v51
  v_pk_fma_f32 v[110:111], v[100:101], v[20:21], v[110:111] op_sel:[0,0,0] op_sel_hi:[1,0,1]
  s_waitcnt vmcnt(10)
  v_lshlrev_b32 v100, 16, v52
  v_and_b32 v101, 0xffff0000, v52
  v_pk_fma_f32 v[104:105], v[100:101], v[20:21], v[104:105] op_sel:[0,1,0] op_sel_hi:[1,1,1]
  v_lshlrev_b32 v100, 16, v53
  v_and_b32 v101, 0xffff0000, v53
  v_pk_fma_f32 v[106:107], v[100:101], v[20:21], v[106:107] op_sel:[0,1,0] op_sel_hi:[1,1,1]
  v_lshlrev_b32 v100, 16, v54
  v_and_b32 v101, 0xffff0000, v54
  v_pk_fma_f32 v[108:109], v[100:101], v[20:21], v[108:109] op_sel:[0,1,0] op_sel_hi:[1,1,1]
  v_lshlrev_b32 v100, 16, v55
  v_and_b32 v101, 0xffff0000, v55
  v_pk_fma_f32 v[110:111], v[100:101], v[20:21], v[110:111] op_sel:[0,1,0] op_sel_hi:[1,1,1]
  s_waitcnt vmcnt(9)
  v_lshlrev_b32 v100, 16, v56
  v_and_b32 v101, 0xffff0000, v56
  v_pk_fma_f32 v[104:105], v[100:101], v[22:23], v[104:105] op_sel:[0,0,0] op_sel_hi:[1,0,1]
  v_lshlrev_b32 v100, 16, v57
  v_and_b32 v101, 0xffff0000, v57
  v_pk_fma_f32 v[106:107], v[100:101], v[22:23], v[106:107] op_sel:[0,0,0] op_sel_hi:[1,0,1]
  v_lshlrev_b32 v100, 16, v58
  v_and_b32 v101, 0xffff0000, v58
  v_pk_fma_f32 v[108:109], v[100:101], v[22:23], v[108:109] op_sel:[0,0,0] op_sel_hi:[1,0,1]
  v_lshlrev_b32 v100, 16, v59
  v_and_b32 v101, 0xffff0000, v59
  v_pk_fma_f32 v[110:111], v[100:101], v[22:23], v[110:111] op_sel:[0,0,0] op_sel_hi:[1,0,1]
  s_waitcnt vmcnt(8)
  v_lshlrev_b32 v100, 16, v60
  v_and_b32 v101, 0xffff0000, v60
  v_pk_fma_f32 v[104:105], v[100:101], v[22:23], v[104:105] op_sel:[0,1,0] op_sel_hi:[1,1,1]
  v_lshlrev_b32 v100, 16, v61
  v_and_b32 v101, 0xffff0000, v61
  v_pk_fma_f32 v[106:107], v[100:101], v[22:23], v[106:107] op_sel:[0,1,0] op_sel_hi:[1,1,1]
  v_lshlrev_b32 v100, 16, v62
  v_and_b32 v101, 0xffff0000, v62
  v_pk_fma_f32 v[108:109], v[100:101], v[22:23], v[108:109] op_sel:[0,1,0] op_sel_hi:[1,1,1]
  v_lshlrev_b32 v100, 16, v63
  v_and_b32 v101, 0xffff0000, v63
  v_pk_fma_f32 v[110:111], v[100:101], v[22:23], v[110:111] op_sel:[0,1,0] op_sel_hi:[1,1,1]
  s_waitcnt vmcnt(7)
  v_lshlrev_b32 v100, 16, v64
  v_and_b32 v101, 0xffff0000, v64
  v_pk_fma_f32 v[104:105], v[100:101], v[24:25], v[104:105] op_sel:[0,0,0] op_sel_hi:[1,0,1]
  v_lshlrev_b32 v100, 16, v65
  v_and_b32 v101, 0xffff0000, v65
  v_pk_fma_f32 v[106:107], v[100:101], v[24:25], v[106:107] op_sel:[0,0,0] op_sel_hi:[1,0,1]
  v_lshlrev_b32 v100, 16, v66
  v_and_b32 v101, 0xffff0000, v66
  v_pk_fma_f32 v[108:109], v[100:101], v[24:25], v[108:109] op_sel:[0,0,0] op_sel_hi:[1,0,1]
  v_lshlrev_b32 v100, 16, v67
  v_and_b32 v101, 0xffff0000, v67
  v_pk_fma_f32 v[110:111], v[100:101], v[24:25], v[110:111] op_sel:[0,0,0] op_sel_hi:[1,0,1]
  s_waitcnt vmcnt(6)
  v_lshlrev_b32 v100, 16, v68
  v_and_b32 v101, 0xffff0000, v68
  v_pk_fma_f32 v[104:105], v[100:101], v[24:25], v[104:105] op_sel:[0,1,0] op_sel_hi:[1,1,1]
  v_lshlrev_b32 v100, 16, v69
  v_and_b32 v101, 0xffff0000, v69
  v_pk_fma_f32 v[106:107], v[100:101], v[24:25], v[106:107] op_sel:[0,1,0] op_sel_hi:[1,1,1]
  v_lshlrev_b32 v100, 16, v70
  v_and_b32 v101, 0xffff0000, v70
  v_pk_fma_f32 v[108:109], v[100:101], v[24:25], v[108:109] op_sel:[0,1,0] op_sel_hi:[1,1,1]
  v_lshlrev_b32 v100, 16, v71
  v_and_b32 v101, 0xffff0000, v71
  v_pk_fma_f32 v[110:111], v[100:101], v[24:25], v[110:111] op_sel:[0,1,0] op_sel_hi:[1,1,1]
  s_waitcnt vmcnt(5)
  v_lshlrev_b32 v100, 16, v72
  v_and_b32 v101, 0xffff0000, v72
  v_pk_fma_f32 v[104:105], v[100:101], v[26:27], v[104:105] op_sel:[0,0,0] op_sel_hi:[1,0,1]
  v_lshlrev_b32 v100, 16, v73
  v_and_b32 v101, 0xffff0000, v73
  v_pk_fma_f32 v[106:107], v[100:101], v[26:27], v[106:107] op_sel:[0,0,0] op_sel_hi:[1,0,1]
  v_lshlrev_b32 v100, 16, v74
  v_and_b32 v101, 0xffff0000, v74
  v_pk_fma_f32 v[108:109], v[100:101], v[26:27], v[108:109] op_sel:[0,0,0] op_sel_hi:[1,0,1]
  v_lshlrev_b32 v100, 16, v75
  v_and_b32 v101, 0xffff0000, v75
  v_pk_fma_f32 v[110:111], v[100:101], v[26:27], v[110:111] op_sel:[0,0,0] op_sel_hi:[1,0,1]
  s_waitcnt vmcnt(4)
  v_lshlrev_b32 v100, 16, v76
  v_and_b32 v101, 0xffff0000, v76
  v_pk_fma_f32 v[104:105], v[100:101], v[26:27], v[104:105] op_sel:[0,1,0] op_sel_hi:[1,1,1]
  v_lshlrev_b32 v100, 16, v77
  v_and_b32 v101, 0xffff0000, v77
  v_pk_fma_f32 v[106:107], v[100:101], v[26:27], v[106:107] op_sel:[0,1,0] op_sel_hi:[1,1,1]
  v_lshlrev_b32 v100, 16, v78
  v_and_b32 v101, 0xffff0000, v78
  v_pk_fma_f32 v[108:109], v[100:101], v[26:27], v[108:109] op_sel:[0,1,0] op_sel_hi:[1,1,1]
  v_lshlrev_b32 v100, 16, v79
  v_and_b32 v101, 0xffff0000, v79
  v_pk_fma_f32 v[110:111], v[100:101], v[26:27], v[110:111] op_sel:[0,1,0] op_sel_hi:[1,1,1]
  s_waitcnt vmcnt(3)
  v_lshlrev_b32 v100, 16, v80
  v_and_b32 v101, 0xffff0000, v80
  v_pk_fma_f32 v[104:105], v[100:101], v[28:29], v[104:105] op_sel:[0,0,0] op_sel_hi:[1,0,1]
  v_lshlrev_b32 v100, 16, v81
  v_and_b32 v101, 0xffff0000, v81
  v_pk_fma_f32 v[106:107], v[100:101], v[28:29], v[106:107] op_sel:[0,0,0] op_sel_hi:[1,0,1]
  v_lshlrev_b32 v100, 16, v82
  v_and_b32 v101, 0xffff0000, v82
  v_pk_fma_f32 v[108:109], v[100:101], v[28:29], v[108:109] op_sel:[0,0,0] op_sel_hi:[1,0,1]
  v_lshlrev_b32 v100, 16, v83
  v_and_b32 v101, 0xffff0000, v83
  v_pk_fma_f32 v[110:111], v[100:101], v[28:29], v[110:111] op_sel:[0,0,0] op_sel_hi:[1,0,1]
  s_waitcnt vmcnt(2)
  v_lshlrev_b32 v100, 16, v84
  v_and_b32 v101, 0xffff0000, v84
  v_pk_fma_f32 v[104:105], v[100:101], v[28:29], v[104:105] op_sel:[0,1,0] op_sel_hi:[1,1,1]
  v_lshlrev_b32 v100, 16, v85
  v_and_b32 v101, 0xffff0000, v85
  v_pk_fma_f32 v[106:107], v[100:101], v[28:29], v[106:107] op_sel:[0,1,0] op_sel_hi:[1,1,1]
  v_lshlrev_b32 v100, 16, v86
  v_and_b32 v101, 0xffff0000, v86
  v_pk_fma_f32 v[108:109], v[100:101], v[28:29], v[108:109] op_sel:[0,1,0] op_sel_hi:[1,1,1]
  v_lshlrev_b32 v100, 16, v87
  v_and_b32 v101, 0xffff0000, v87
  v_pk_fma_f32 v[110:111], v[100:101], v[28:29], v[110:111] op_sel:[0,1,0] op_sel_hi:[1,1,1]
  s_waitcnt vmcnt(1)
  v_lshlrev_b32 v100, 16, v88
  v_and_b32 v101, 0xffff0000, v88
  v_pk_fma_f32 v[104:105], v[100:101], v[30:31], v[104:105] op_sel:[0,0,0] op_sel_hi:[1,0,1]
  v_lshlrev_b32 v100, 16, v89
  v_and_b32 v101, 0xffff0000, v89
  v_pk_fma_f32 v[106:107], v[100:101], v[30:31], v[106:107] op_sel:[0,0,0] op_sel_hi:[1,0,1]
  v_lshlrev_b32 v100, 16, v90
  v_and_b32 v101, 0xffff0000, v90
  v_pk_fma_f32 v[108:109], v[100:101], v[30:31], v[108:109] op_sel:[0,0,0] op_sel_hi:[1,0,1]
  v_lshlrev_b32 v100, 16, v91
  v_and_b32 v101, 0xffff0000, v91
  v_pk_fma_f32 v[110:111], v[100:101], v[30:31], v[110:111] op_sel:[0,0,0] op_sel_hi:[1,0,1]
  s_waitcnt vmcnt(0)
  v_lshlrev_b32 v100, 16, v92
  v_and_b32 v101, 0xffff0000, v92
  v_pk_fma_f32 v[104:105], v[100:101], v[30:31], v[104:105] op_sel:[0,1,0] op_sel_hi:[1,1,1]
  v_lshlrev_b32 v100, 16, v93
  v_and_b32 v101, 0xffff0000, v93
  v_pk_fma_f32 v[106:107], v[100:101], v[30:31], v[106:107] op_sel:[0,1,0] op_sel_hi:[1,1,1]
  v_lshlrev_b32 v100, 16, v94
  v_and_b32 v101, 0xffff0000, v94
  v_pk_fma_f32 v[108:109], v[100:101], v[30:31], v[108:109] op_sel:[0,1,0] op_sel_hi:[1,1,1]
  v_lshlrev_b32 v100, 16, v95
  v_and_b32 v101, 0xffff0000, v95
  v_pk_fma_f32 v[110:111], v[100:101], v[30:31], v[110:111] op_sel:[0,1,0] op_sel_hi:[1,1,1]
  v_permlane32_swap_b32 v104, v108
  v_permlane32_swap_b32 v105, v109
  v_permlane32_swap_b32 v106, v110
  v_permlane32_swap_b32 v107, v111
  v_add_f32 v104, v104, v108
  v_add_f32 v105, v105, v109
  v_add_f32 v106, v106, v110
  v_add_f32 v107, v107, v111
  s_nop 0
  v_permlane16_swap_b32 v104, v106
  v_permlane16_swap_b32 v105, v107
  v_add_f32 v104, v104, v106
  v_add_f32 v105, v105, v107
  s_nop 0
  v_add_f32_dpp v104, v104, v104 row_ror:8 row_mask:0xf bank_mask:0xf
  v_add_f32_dpp v105, v105, v105 row_ror:8 row_mask:0xf bank_mask:0xf
  s_nop 0
  v_add_f32_dpp v104, v104, v104 row_ror:4 row_mask:0xf bank_mask:0xf
  v_add_f32_dpp v105, v105, v105 row_ror:4 row_mask:0xf bank_mask:0xf
  s_nop 0
  v_add_f32_dpp v104, v104, v104 row_ror:2 row_mask:0xf bank_mask:0xf
  v_add_f32_dpp v105, v105, v105 row_ror:2 row_mask:0xf bank_mask:0xf
  v_cvt_pk_bf16_f32 v104, v104, v104
  v_lshlrev_b32 v104, 16, v104
  v_cvt_pk_bf16_f32 v105, v105, v105
  v_lshlrev_b32 v105, 16, v105
  v_lshrrev_b32 v6, 4, v1
  v_lshlrev_b32 v6, 3, v6
  v_lshl_add_u32 v6, v4, 5, v6
  s_lshl_b32 s29, s28, 6
  s_add_u32 s29, s29, 0x1310000
  v_and_b32 v8, 14, v1
  v_cmp_eq_u32 vcc, 0, v8
  s_and_saveexec_b64 s[44:45], vcc
  buffer_store_dwordx2 v[104:105], v6, s[36:39], s29 offen sc1
  s_mov_b64 exec, s[44:45]
R_SIG:
  s_waitcnt vmcnt(0)
  v_mov_b32 v8, 163808
  v_mov_b32 v9, 1
  s_mov_b64 s[44:45], exec
  s_mov_b64 exec, 1
  ds_add_rtn_u32 v9, v8, v9
  s_waitcnt lgkmcnt(0)
  s_mov_b64 exec, s[44:45]
  v_readfirstlane_b32 s26, v9
  s_cmp_lg_u32 s26, 2
  s_cbranch_scc1 R_END
  v_mov_b32 v176, 163824
R_TAG:
  ds_read_b64 v[178:179], v176
  s_waitcnt lgkmcnt(0)
  v_readfirstlane_b32 s40, v178
  v_readfirstlane_b32 s41, v179
  s_cmp_lg_u32 s40, 0
  s_cbranch_scc1 R_TAG_D
  s_sleep 2
  s_branch R_TAG
R_TAG_D:
  s_add_u32 s43, s46, 0x1330000
  v_lshl_add_u32 v176, v1, 11, s43
  v_mov_b32 v178, s40
  v_mov_b32 v179, s41
  s_mov_b64 exec, 0xffff
  global_store_dwordx2 v176, v[178:179], s[4:5] sc1
  s_mov_b64 exec, -1
  s_branch R_END
R_W2:
  s_mov_b32 s40, 0
  s_cmp_ge_u32 s2, 224
  s_cbranch_scc1 R_W2T
  s_mov_b64 s[24:25], s[68:69]
  s_mov_b32 s28, s31
  s_mul_i32 s29, s28, 0x5556
  s_lshr_b32 s29, s29, 16
  s_lshl_b32 s30, s28, 1
  s_add_u32 s29, s29, s30
  s_mov_b32 s30, 1
  s_cmp_lt_u32 s28, 48
  s_cbranch_scc1 R_W2a
  s_sub_u32 s29, s28, 48
  s_mul_i32 s29, s29, 14
  s_add_u32 s29, s29, 6
  s_mov_b32 s30, 7
R_W2a:
  s_lshl_b32 s29, s29, 14
  s_lshl_b32 s30, s30, 14
  v_and_b32 v4, 1, v2
  v_lshlrev_b32 v4, 13, v4
  v_lshrrev_b32 v5, 1, v2
  v_lshl_add_u32 v4, v5, 10, v4
  v_lshl_add_u32 v4, v1, 4, v4
  v_add_u32 v4, s29, v4
  v_add_u32 v5, 0x1000, v4
  v_add_u32 v6, s30, v4
  v_add_u32 v7, s30, v5
  global_load_dwordx4 v[16:19], v4, s[24:25] offset:0
  global_load_dwordx4 v[20:23], v4, s[24:25] offset:2048
  global_load_dwordx4 v[24:27], v5, s[24:25] offset:0
  global_load_dwordx4 v[28:31], v5, s[24:25] offset:2048
  global_load_dwordx4 v[32:35], v6, s[24:25] offset:0
  global_load_dwordx4 v[36:39], v6, s[24:25] offset:2048
  global_load_dwordx4 v[40:43], v7, s[24:25] offset:0
  global_load_dwordx4 v[44:47], v7, s[24:25] offset:2048
  v_mov_b32 v8, 0
  v_lshrrev_b32 v9, 5, v1
  v_mul_u32_u24 v9, 4160, v9
  v_add_u32 v9, v9, v8
  v_bfe_u32 v10, v1, 3, 2
  v_lshl_add_u32 v9, v10, 10, v9
  v_and_b32 v10, 1, v1
  v_lshl_add_u32 v9, v10, 9, v9
  v_bfe_u32 v10, v1, 1, 2
  v_lshl_add_u32 v9, v10, 6, v9
  v_lshl_add_u32 v8, v1, 4, v8
  v_lshrrev_b32 v6, 4, v1
  v_lshlrev_b32 v6, 10, v6
  v_and_b32 v7, 15, v1
  v_lshl_add_u32 v6, v7, 4, v6
  v_lshl_add_u32 v6, v2, 8, v6
  s_lshl_b32 s29, s28, 12
  s_add_u32 s29, s29, 0xa00000
  s_waitcnt vmcnt(0)
  v_mov_b32 v176, s35
  global_load_dwordx2 v[178:179], v176, s[6:7] sc1
  v_perm_b32 v48, v20, v16, s20
  v_perm_b32 v49, v28, v24, s20
  v_perm_b32 v50, v36, v32, s20
  v_perm_b32 v51, v44, v40, s20
  v_perm_b32 v52, v20, v16, s21
  v_perm_b32 v53, v28, v24, s21
  v_perm_b32 v54, v36, v32, s21
  v_perm_b32 v55, v44, v40, s21
  v_perm_b32 v56, v21, v17, s20
  v_perm_b32 v57, v29, v25, s20
  v_perm_b32 v58, v37, v33, s20
  v_perm_b32 v59, v45, v41, s20
  v_perm_b32 v60, v21, v17, s21
  v_perm_b32 v61, v29, v25, s21
  v_perm_b32 v62, v37, v33, s21
  v_perm_b32 v63, v45, v41, s21
  v_perm_b32 v64, v22, v18, s20
  v_perm_b32 v65, v30, v26, s20
  v_perm_b32 v66, v38, v34, s20
  v_perm_b32 v67, v46, v42, s20
  v_perm_b32 v68, v22, v18, s21
  v_perm_b32 v69, v30, v26, s21
  v_perm_b32 v70, v38, v34, s21
  v_perm_b32 v71, v46, v42, s21
  v_perm_b32 v72, v23, v19, s20
  v_perm_b32 v73, v31, v27, s20
  v_perm_b32 v74, v39, v35, s20
  v_perm_b32 v75, v47, v43, s20
  v_perm_b32 v76, v23, v19, s21
  v_perm_b32 v77, v31, v27, s21
  v_perm_b32 v78, v39, v35, s21
  v_perm_b32 v79, v47, v43, s21
  ds_write_b128 v9, v[48:51] offset:0
  ds_write_b128 v9, v[52:55] offset:16
  ds_write_b128 v9, v[56:59] offset:32
  ds_write_b128 v9, v[60:63] offset:48
  ds_write_b128 v9, v[64:67] offset:256
  ds_write_b128 v9, v[68:71] offset:272
  ds_write_b128 v9, v[72:75] offset:288
  ds_write_b128 v9, v[76:79] offset:304
  s_waitcnt lgkmcnt(0)
  s_waitcnt vmcnt(0)
  v_readfirstlane_b32 s40, v178
  v_mov_b32 v176, 163824
  ds_write_b64 v176, v[178:179]
  ds_read_b128 v[16:19], v8 offset:0
  ds_read_b128 v[20:23], v8 offset:1024
  ds_read_b128 v[24:27], v8 offset:2048
  ds_read_b128 v[28:31], v8 offset:3072
  ds_read_b128 v[32:35], v8 offset:4160
  ds_read_b128 v[36:39], v8 offset:5184
  ds_read_b128 v[40:43], v8 offset:6208
  ds_read_b128 v[44:47], v8 offset:7232
  s_waitcnt lgkmcnt(7)
  buffer_store_dwordx4 v[16:19], v6, s[36:39], s29 offen sc1
  s_add_u32 s29, s29, 229376
  s_waitcnt lgkmcnt(6)
  buffer_store_dwordx4 v[20:23], v6, s[36:39], s29 offen sc1
  s_add_u32 s29, s29, 229376
  s_waitcnt lgkmcnt(5)
  buffer_store_dwordx4 v[24:27], v6, s[36:39], s29 offen sc1
  s_add_u32 s29, s29, 229376
  s_waitcnt lgkmcnt(4)
  buffer_store_dwordx4 v[28:31], v6, s[36:39], s29 offen sc1
  s_add_u32 s29, s29, 229376
  s_waitcnt lgkmcnt(3)
  buffer_store_dwordx4 v[32:35], v6, s[36:39], s29 offen sc1
  s_add_u32 s29, s29, 229376
  s_waitcnt lgkmcnt(2)
  buffer_store_dwordx4 v[36:39], v6, s[36:39], s29 offen sc1
  s_add_u32 s29, s29, 229376
  s_waitcnt lgkmcnt(1)
  buffer_store_dwordx4 v[40:43], v6, s[36:39], s29 offen sc1
  s_add_u32 s29, s29, 229376
  s_waitcnt lgkmcnt(0)
  buffer_store_dwordx4 v[44:47], v6, s[36:39], s29 offen sc1
  s_add_u32 s29, s29, 229376
R_W2T:
  s_cmp_lg_u32 s40, 0
  s_cbranch_scc1 R_END
  s_waitcnt vmcnt(0)
  v_mov_b32 v176, s35
  s_mov_b32 s42, 0
R_TG:
  global_load_dwordx2 v[178:179], v176, s[6:7] sc1
  s_waitcnt vmcnt(0)
  v_readfirstlane_b32 s40, v178
  v_readfirstlane_b32 s41, v179
  s_add_u32 s42, s42, 1
  s_cmp_gt_u32 s42, 0x40000
  s_cbranch_scc1 R_TG_D
  s_cmp_lg_u32 s40, 0
  s_cbranch_scc1 R_TG_D
  s_sleep 16
  s_branch R_TG
R_TG_D:
  v_or_b32 v178, 1, v178
  v_mov_b32 v176, 163824
  ds_write_b64 v176, v[178:179]
R_END:
  v_and_b32 v3, 255, v0
  s_lshr_b32 s25, s3, 2
  v_and_b32 v52, 15, v1
  v_lshrrev_b32 v53, 4, v1
  s_cmp_ge_u32 s3, 4
  s_cbranch_scc1 KG_END
  v_lshl_add_u32 v58, v3, 3, 0
  v_cvt_f32_u32 v58, v58
  v_cvt_pk_bf16_f32 v58, v58, v58
  v_lshlrev_b32 v58, 16, v58
  v_cvt_u32_f32 v58, v58
  v_bfe_u32 v59, v58, 4, 5
  v_and_b32 v54, 15, v58
  v_lshrrev_b32 v55, 9, v58
  v_lshrrev_b32 v56, 2, v54
  v_lshl_add_u32 v56, v55, 2, v56
  v_add_u32 v56, 12, v56
  v_cmp_eq_u32 vcc, 0, v55
  s_nop 1
  v_cndmask_b32 v54, v56, v54, vcc
  v_lshlrev_b32 v59, 6, v59
  v_lshl_add_u32 v59, v54, 1, v59
  v_add_u32 v44, 76800, v59
  v_lshl_add_u32 v58, v3, 3, 1
  v_cvt_f32_u32 v58, v58
  v_cvt_pk_bf16_f32 v58, v58, v58
  v_lshlrev_b32 v58, 16, v58
  v_cvt_u32_f32 v58, v58
  v_bfe_u32 v59, v58, 4, 5
  v_and_b32 v54, 15, v58
  v_lshrrev_b32 v55, 9, v58
  v_lshrrev_b32 v56, 2, v54
  v_lshl_add_u32 v56, v55, 2, v56
  v_add_u32 v56, 12, v56
  v_cmp_eq_u32 vcc, 0, v55
  s_nop 1
  v_cndmask_b32 v54, v56, v54, vcc
  v_lshlrev_b32 v59, 6, v59
  v_lshl_add_u32 v59, v54, 1, v59
  v_add_u32 v45, 76800, v59
  v_lshl_add_u32 v58, v3, 3, 2
  v_cvt_f32_u32 v58, v58
  v_cvt_pk_bf16_f32 v58, v58, v58
  v_lshlrev_b32 v58, 16, v58
  v_cvt_u32_f32 v58, v58
  v_bfe_u32 v59, v58, 4, 5
  v_and_b32 v54, 15, v58
  v_lshrrev_b32 v55, 9, v58
  v_lshrrev_b32 v56, 2, v54
  v_lshl_add_u32 v56, v55, 2, v56
  v_add_u32 v56, 12, v56
  v_cmp_eq_u32 vcc, 0, v55
  s_nop 1
  v_cndmask_b32 v54, v56, v54, vcc
  v_lshlrev_b32 v59, 6, v59
  v_lshl_add_u32 v59, v54, 1, v59
  v_add_u32 v46, 76800, v59
  v_lshl_add_u32 v58, v3, 3, 3
  v_cvt_f32_u32 v58, v58
  v_cvt_pk_bf16_f32 v58, v58, v58
  v_lshlrev_b32 v58, 16, v58
  v_cvt_u32_f32 v58, v58
  v_bfe_u32 v59, v58, 4, 5
  v_and_b32 v54, 15, v58
  v_lshrrev_b32 v55, 9, v58
  v_lshrrev_b32 v56, 2, v54
  v_lshl_add_u32 v56, v55, 2, v56
  v_add_u32 v56, 12, v56
  v_cmp_eq_u32 vcc, 0, v55
  s_nop 1
  v_cndmask_b32 v54, v56, v54, vcc
  v_lshlrev_b32 v59, 6, v59
  v_lshl_add_u32 v59, v54, 1, v59
  v_add_u32 v47, 76800, v59
  v_lshl_add_u32 v58, v3, 3, 4
  v_cvt_f32_u32 v58, v58
  v_cvt_pk_bf16_f32 v58, v58, v58
  v_lshlrev_b32 v58, 16, v58
  v_cvt_u32_f32 v58, v58
  v_bfe_u32 v59, v58, 4, 5
  v_and_b32 v54, 15, v58
  v_lshrrev_b32 v55, 9, v58
  v_lshrrev_b32 v56, 2, v54
  v_lshl_add_u32 v56, v55, 2, v56
  v_add_u32 v56, 12, v56
  v_cmp_eq_u32 vcc, 0, v55
  s_nop 1
  v_cndmask_b32 v54, v56, v54, vcc
  v_lshlrev_b32 v59, 6, v59
  v_lshl_add_u32 v59, v54, 1, v59
  v_add_u32 v48, 76800, v59
  v_lshl_add_u32 v58, v3, 3, 5
  v_cvt_f32_u32 v58, v58
  v_cvt_pk_bf16_f32 v58, v58, v58
  v_lshlrev_b32 v58, 16, v58
  v_cvt_u32_f32 v58, v58
  v_bfe_u32 v59, v58, 4, 5
  v_and_b32 v54, 15, v58
  v_lshrrev_b32 v55, 9, v58
  v_lshrrev_b32 v56, 2, v54
  v_lshl_add_u32 v56, v55, 2, v56
  v_add_u32 v56, 12, v56
  v_cmp_eq_u32 vcc, 0, v55
  s_nop 1
  v_cndmask_b32 v54, v56, v54, vcc
  v_lshlrev_b32 v59, 6, v59
  v_lshl_add_u32 v59, v54, 1, v59
  v_add_u32 v49, 76800, v59
  v_lshl_add_u32 v58, v3, 3, 6
  v_cvt_f32_u32 v58, v58
  v_cvt_pk_bf16_f32 v58, v58, v58
  v_lshlrev_b32 v58, 16, v58
  v_cvt_u32_f32 v58, v58
  v_bfe_u32 v59, v58, 4, 5
  v_and_b32 v54, 15, v58
  v_lshrrev_b32 v55, 9, v58
  v_lshrrev_b32 v56, 2, v54
  v_lshl_add_u32 v56, v55, 2, v56
  v_add_u32 v56, 12, v56
  v_cmp_eq_u32 vcc, 0, v55
  s_nop 1
  v_cndmask_b32 v54, v56, v54, vcc
  v_lshlrev_b32 v59, 6, v59
  v_lshl_add_u32 v59, v54, 1, v59
  v_add_u32 v50, 76800, v59
  v_lshl_add_u32 v58, v3, 3, 7
  v_cvt_f32_u32 v58, v58
  v_cvt_pk_bf16_f32 v58, v58, v58
  v_lshlrev_b32 v58, 16, v58
  v_cvt_u32_f32 v58, v58
  v_bfe_u32 v59, v58, 4, 5
  v_and_b32 v54, 15, v58
  v_lshrrev_b32 v55, 9, v58
  v_lshrrev_b32 v56, 2, v54
  v_lshl_add_u32 v56, v55, 2, v56
  v_add_u32 v56, 12, v56
  v_cmp_eq_u32 vcc, 0, v55
  s_nop 1
  v_cndmask_b32 v54, v56, v54, vcc
  v_lshlrev_b32 v59, 6, v59
  v_lshl_add_u32 v59, v54, 1, v59
  v_add_u32 v51, 76800, v59
  v_mov_b32 v60, 0
  v_mov_b32 v61, 0
  v_mov_b32 v62, 0
  v_mov_b32 v63, 0
  s_cmp_ge_u32 s3, 3
  s_cbranch_scc1 K2_NZ
  s_cmp_eq_u32 s3, 2
  s_cbranch_scc1 K2_ZH
  s_mul_i32 s27, s3, 5120
  s_add_u32 s27, s27, 66560
  v_lshrrev_b32 v56, 4, v1
  v_mul_u32_u24 v56, 1280, v56
  v_and_b32 v57, 15, v1
  v_lshl_add_u32 v56, v57, 4, v56
  v_add_u32 v56, s27, v56
  ds_write_b128 v56, v[60:63]
  s_branch K2_NZ
K2_ZH:
  v_lshrrev_b32 v56, 2, v1
  v_mul_u32_u24 v56, 4160, v56
  v_and_b32 v57, 3, v1
  v_lshl_add_u32 v56, v57, 4, v56
  ds_write_b128 v56, v[60:63] offset:4096
K2_NZ:
  v_lshrrev_b32 v56, 7, v3
  v_mul_u32_u24 v56, 33792, v56
  v_and_b32 v57, 127, v3
  v_lshl_add_u32 v56, v57, 2, v56
  v_add_u32 v56, 80896, v56
  s_waitcnt vmcnt(4)
  v_lshlrev_b32 v10, 16, v120
  v_lshlrev_b32 v11, 16, v121
  v_lshlrev_b32 v12, 16, v122
  v_lshlrev_b32 v13, 16, v123
  v_lshlrev_b32 v14, 16, v124
  v_lshlrev_b32 v15, 16, v125
  v_lshlrev_b32 v16, 16, v126
  v_mul_f32 v16, 0x3fb8aa3b, v16
  v_exp_f32 v16, v16
  s_nop 0
  v_cvt_pk_bf16_f32 v16, v16, v16
  v_lshlrev_b32 v16, 16, v16
  v_mul_f32 v10, v10, v16
  v_mul_f32 v11, v11, v16
  v_mul_f32 v10, 0x3fb8aa3b, v10
  v_mul_f32 v11, 0.15915494, v11
  v_mul_f32 v12, v12, v16
  v_mul_f32 v13, v13, v16
  v_mul_f32 v58, v15, v13
  v_mul_f32 v59, v15, v12
  v_fma_f32 v60, v14, v12, -v58
  v_fma_f32 v61, v14, v13, v59
  v_mul_f32 v58, 0x41800000, v10
  v_mul_f32 v59, 0x41800000, v11
  v_exp_f32 v58, v58
  v_fract_f32 v59, v59
  v_cos_f32 v64, v59
  v_sin_f32 v65, v59
  v_mul_f32 v64, v64, v58
  v_mul_f32 v65, v65, v58
  v_mul_f32 v58, 0x43800000, v10
  v_mul_f32 v59, 0x43800000, v11
  v_exp_f32 v58, v58
  v_fract_f32 v59, v59
  v_cos_f32 v66, v59
  v_sin_f32 v67, v59
  v_mul_f32 v66, v66, v58
  v_mul_f32 v67, v67, v58
  v_mul_f32 v58, v61, v67
  v_mul_f32 v59, v61, v66
  v_fma_f32 v68, v60, v66, -v58
  v_fma_f32 v69, v60, v67, v59
  v_cvt_pk_bf16_f32 v72, v60, v61
  v_cvt_pk_bf16_f32 v73, v68, v69
  v_mul_f32 v58, v61, v65
  v_mul_f32 v59, v61, v64
  v_fma_f32 v62, v60, v64, -v58
  v_fma_f32 v63, v60, v65, v59
  v_mul_f32 v74, v69, v65
  v_mul_f32 v75, v69, v64
  v_fma_f32 v70, v68, v64, -v74
  v_fma_f32 v71, v68, v65, v75
  ds_write_b32 v56, v72 offset:0
  ds_write_b32 v56, v73 offset:8448
  v_cvt_pk_bf16_f32 v72, v62, v63
  v_cvt_pk_bf16_f32 v73, v70, v71
  v_mul_f32 v58, v63, v65
  v_mul_f32 v59, v63, v64
  v_fma_f32 v60, v62, v64, -v58
  v_fma_f32 v61, v62, v65, v59
  v_mul_f32 v74, v71, v65
  v_mul_f32 v75, v71, v64
  v_fma_f32 v68, v70, v64, -v74
  v_fma_f32 v69, v70, v65, v75
  ds_write_b32 v56, v72 offset:528
  ds_write_b32 v56, v73 offset:8976
  v_cvt_pk_bf16_f32 v72, v60, v61
  v_cvt_pk_bf16_f32 v73, v68, v69
  v_mul_f32 v58, v61, v65
  v_mul_f32 v59, v61, v64
  v_fma_f32 v62, v60, v64, -v58
  v_fma_f32 v63, v60, v65, v59
  v_mul_f32 v74, v69, v65
  v_mul_f32 v75, v69, v64
  v_fma_f32 v70, v68, v64, -v74
  v_fma_f32 v71, v68, v65, v75
  ds_write_b32 v56, v72 offset:1056
  ds_write_b32 v56, v73 offset:9504
  v_cvt_pk_bf16_f32 v72, v62, v63
  v_cvt_pk_bf16_f32 v73, v70, v71
  v_mul_f32 v58, v63, v65
  v_mul_f32 v59, v63, v64
  v_fma_f32 v60, v62, v64, -v58
  v_fma_f32 v61, v62, v65, v59
  v_mul_f32 v74, v71, v65
  v_mul_f32 v75, v71, v64
  v_fma_f32 v68, v70, v64, -v74
  v_fma_f32 v69, v70, v65, v75
  ds_write_b32 v56, v72 offset:1584
  ds_write_b32 v56, v73 offset:10032
  v_cvt_pk_bf16_f32 v72, v60, v61
  v_cvt_pk_bf16_f32 v73, v68, v69
  v_mul_f32 v58, v61, v65
  v_mul_f32 v59, v61, v64
  v_fma_f32 v62, v60, v64, -v58
  v_fma_f32 v63, v60, v65, v59
  v_mul_f32 v74, v69, v65
  v_mul_f32 v75, v69, v64
  v_fma_f32 v70, v68, v64, -v74
  v_fma_f32 v71, v68, v65, v75
  ds_write_b32 v56, v72 offset:2112
  ds_write_b32 v56, v73 offset:10560
  v_cvt_pk_bf16_f32 v72, v62, v63
  v_cvt_pk_bf16_f32 v73, v70, v71
  v_mul_f32 v58, v63, v65
  v_mul_f32 v59, v63, v64
  v_fma_f32 v60, v62, v64, -v58
  v_fma_f32 v61, v62, v65, v59
  v_mul_f32 v74, v71, v65
  v_mul_f32 v75, v71, v64
  v_fma_f32 v68, v70, v64, -v74
  v_fma_f32 v69, v70, v65, v75
  ds_write_b32 v56, v72 offset:2640
  ds_write_b32 v56, v73 offset:11088
  v_cvt_pk_bf16_f32 v72, v60, v61
  v_cvt_pk_bf16_f32 v73, v68, v69
  v_mul_f32 v58, v61, v65
  v_mul_f32 v59, v61, v64
  v_fma_f32 v62, v60, v64, -v58
  v_fma_f32 v63, v60, v65, v59
  v_mul_f32 v74, v69, v65
  v_mul_f32 v75, v69, v64
  v_fma_f32 v70, v68, v64, -v74
  v_fma_f32 v71, v68, v65, v75
  ds_write_b32 v56, v72 offset:3168
  ds_write_b32 v56, v73 offset:11616
  v_cvt_pk_bf16_f32 v72, v62, v63
  v_cvt_pk_bf16_f32 v73, v70, v71
  v_mul_f32 v58, v63, v65
  v_mul_f32 v59, v63, v64
  v_fma_f32 v60, v62, v64, -v58
  v_fma_f32 v61, v62, v65, v59
  v_mul_f32 v74, v71, v65
  v_mul_f32 v75, v71, v64
  v_fma_f32 v68, v70, v64, -v74
  v_fma_f32 v69, v70, v65, v75
  ds_write_b32 v56, v72 offset:3696
  ds_write_b32 v56, v73 offset:12144
  v_cvt_pk_bf16_f32 v72, v60, v61
  v_cvt_pk_bf16_f32 v73, v68, v69
  v_mul_f32 v58, v61, v65
  v_mul_f32 v59, v61, v64
  v_fma_f32 v62, v60, v64, -v58
  v_fma_f32 v63, v60, v65, v59
  v_mul_f32 v74, v69, v65
  v_mul_f32 v75, v69, v64
  v_fma_f32 v70, v68, v64, -v74
  v_fma_f32 v71, v68, v65, v75
  ds_write_b32 v56, v72 offset:4224
  ds_write_b32 v56, v73 offset:12672
  v_cvt_pk_bf16_f32 v72, v62, v63
  v_cvt_pk_bf16_f32 v73, v70, v71
  v_mul_f32 v58, v63, v65
  v_mul_f32 v59, v63, v64
  v_fma_f32 v60, v62, v64, -v58
  v_fma_f32 v61, v62, v65, v59
  v_mul_f32 v74, v71, v65
  v_mul_f32 v75, v71, v64
  v_fma_f32 v68, v70, v64, -v74
  v_fma_f32 v69, v70, v65, v75
  ds_write_b32 v56, v72 offset:4752
  ds_write_b32 v56, v73 offset:13200
  v_cvt_pk_bf16_f32 v72, v60, v61
  v_cvt_pk_bf16_f32 v73, v68, v69
  v_mul_f32 v58, v61, v65
  v_mul_f32 v59, v61, v64
  v_fma_f32 v62, v60, v64, -v58
  v_fma_f32 v63, v60, v65, v59
  v_mul_f32 v74, v69, v65
  v_mul_f32 v75, v69, v64
  v_fma_f32 v70, v68, v64, -v74
  v_fma_f32 v71, v68, v65, v75
  ds_write_b32 v56, v72 offset:5280
  ds_write_b32 v56, v73 offset:13728
  v_cvt_pk_bf16_f32 v72, v62, v63
  v_cvt_pk_bf16_f32 v73, v70, v71
  v_mul_f32 v58, v63, v65
  v_mul_f32 v59, v63, v64
  v_fma_f32 v60, v62, v64, -v58
  v_fma_f32 v61, v62, v65, v59
  v_mul_f32 v74, v71, v65
  v_mul_f32 v75, v71, v64
  v_fma_f32 v68, v70, v64, -v74
  v_fma_f32 v69, v70, v65, v75
  ds_write_b32 v56, v72 offset:5808
  ds_write_b32 v56, v73 offset:14256
  v_cvt_pk_bf16_f32 v72, v60, v61
  v_cvt_pk_bf16_f32 v73, v68, v69
  v_mul_f32 v58, v61, v65
  v_mul_f32 v59, v61, v64
  v_fma_f32 v62, v60, v64, -v58
  v_fma_f32 v63, v60, v65, v59
  v_mul_f32 v74, v69, v65
  v_mul_f32 v75, v69, v64
  v_fma_f32 v70, v68, v64, -v74
  v_fma_f32 v71, v68, v65, v75
  ds_write_b32 v56, v72 offset:6336
  ds_write_b32 v56, v73 offset:14784
  v_cvt_pk_bf16_f32 v72, v62, v63
  v_cvt_pk_bf16_f32 v73, v70, v71
  v_mul_f32 v58, v63, v65
  v_mul_f32 v59, v63, v64
  v_fma_f32 v60, v62, v64, -v58
  v_fma_f32 v61, v62, v65, v59
  v_mul_f32 v74, v71, v65
  v_mul_f32 v75, v71, v64
  v_fma_f32 v68, v70, v64, -v74
  v_fma_f32 v69, v70, v65, v75
  ds_write_b32 v56, v72 offset:6864
  ds_write_b32 v56, v73 offset:15312
  v_cvt_pk_bf16_f32 v72, v60, v61
  v_cvt_pk_bf16_f32 v73, v68, v69
  v_mul_f32 v58, v61, v65
  v_mul_f32 v59, v61, v64
  v_fma_f32 v62, v60, v64, -v58
  v_fma_f32 v63, v60, v65, v59
  v_mul_f32 v74, v69, v65
  v_mul_f32 v75, v69, v64
  v_fma_f32 v70, v68, v64, -v74
  v_fma_f32 v71, v68, v65, v75
  ds_write_b32 v56, v72 offset:7392
  ds_write_b32 v56, v73 offset:15840
  v_cvt_pk_bf16_f32 v72, v62, v63
  v_cvt_pk_bf16_f32 v73, v70, v71
  ds_write_b32 v56, v72 offset:7920
  ds_write_b32 v56, v73 offset:16368
  v_mov_b32 v72, 0x3f80
  ds_write_b32 v56, v72 offset:16896
  v_mul_f32 v58, 0x3f800000, v10
  v_mul_f32 v59, 0x3f800000, v11
  v_exp_f32 v58, v58
  v_fract_f32 v59, v59
  v_cos_f32 v82, v59
  v_sin_f32 v83, v59
  v_mul_f32 v82, v82, v58
  v_mul_f32 v83, v83, v58
  v_mul_f32 v58, 0x41000000, v10
  v_mul_f32 v59, 0x41000000, v11
  v_exp_f32 v58, v58
  v_fract_f32 v59, v59
  v_cos_f32 v96, v59
  v_sin_f32 v97, v59
  v_mul_f32 v96, v96, v58
  v_mul_f32 v97, v97, v58
  v_mul_f32 v58, 0x44000000, v10
  v_mul_f32 v59, 0x44000000, v11
  v_exp_f32 v58, v58
  v_fract_f32 v59, v59
  v_cos_f32 v76, v59
  v_sin_f32 v77, v59
  v_mul_f32 v76, v76, v58
  v_mul_f32 v77, v77, v58
  v_mul_f32 v58, 0x44800000, v10
  v_mul_f32 v59, 0x44800000, v11
  v_exp_f32 v58, v58
  v_fract_f32 v59, v59
  v_cos_f32 v78, v59
  v_sin_f32 v79, v59
  v_mul_f32 v78, v78, v58
  v_mul_f32 v79, v79, v58
  v_cvt_pk_bf16_f32 v72, v82, -v83
  ds_write_b32 v56, v72 offset:17424
  v_cvt_pk_bf16_f32 v72, v96, -v97
  ds_write_b32 v56, v72 offset:21120
  v_mul_f32 v58, v83, v83
  v_mul_f32 v59, v83, v82
  v_fma_f32 v84, v82, v82, -v58
  v_fma_f32 v85, v82, v83, v59
  v_mul_f32 v74, v97, v83
  v_mul_f32 v75, v97, v82
  v_fma_f32 v98, v96, v82, -v74
  v_fma_f32 v99, v96, v83, v75
  v_cvt_pk_bf16_f32 v72, v84, -v85
  ds_write_b32 v56, v72 offset:17952
  v_cvt_pk_bf16_f32 v72, v98, -v99
  ds_write_b32 v56, v72 offset:21648
  v_mul_f32 v58, v85, v83
  v_mul_f32 v59, v85, v82
  v_fma_f32 v86, v84, v82, -v58
  v_fma_f32 v87, v84, v83, v59
  v_mul_f32 v74, v99, v83
  v_mul_f32 v75, v99, v82
  v_fma_f32 v100, v98, v82, -v74
  v_fma_f32 v101, v98, v83, v75
  v_cvt_pk_bf16_f32 v72, v86, -v87
  ds_write_b32 v56, v72 offset:18480
  v_cvt_pk_bf16_f32 v72, v100, -v101
  ds_write_b32 v56, v72 offset:22176
  v_mul_f32 v58, v87, v83
  v_mul_f32 v59, v87, v82
  v_fma_f32 v88, v86, v82, -v58
  v_fma_f32 v89, v86, v83, v59
  v_mul_f32 v74, v101, v83
  v_mul_f32 v75, v101, v82
  v_fma_f32 v102, v100, v82, -v74
  v_fma_f32 v103, v100, v83, v75
  v_cvt_pk_bf16_f32 v72, v88, -v89
  ds_write_b32 v56, v72 offset:19008
  v_cvt_pk_bf16_f32 v72, v102, -v103
  ds_write_b32 v56, v72 offset:22704
  v_mul_f32 v58, v89, v83
  v_mul_f32 v59, v89, v82
  v_fma_f32 v90, v88, v82, -v58
  v_fma_f32 v91, v88, v83, v59
  v_mul_f32 v74, v103, v83
  v_mul_f32 v75, v103, v82
  v_fma_f32 v104, v102, v82, -v74
  v_fma_f32 v105, v102, v83, v75
  v_cvt_pk_bf16_f32 v72, v90, -v91
  ds_write_b32 v56, v72 offset:19536
  v_cvt_pk_bf16_f32 v72, v104, -v105
  ds_write_b32 v56, v72 offset:23232
  v_mul_f32 v58, v91, v83
  v_mul_f32 v59, v91, v82
  v_fma_f32 v92, v90, v82, -v58
  v_fma_f32 v93, v90, v83, v59
  v_mul_f32 v74, v105, v83
  v_mul_f32 v75, v105, v82
  v_fma_f32 v106, v104, v82, -v74
  v_fma_f32 v107, v104, v83, v75
  v_cvt_pk_bf16_f32 v72, v92, -v93
  ds_write_b32 v56, v72 offset:20064
  v_cvt_pk_bf16_f32 v72, v106, -v107
  ds_write_b32 v56, v72 offset:23760
  v_mul_f32 v58, v93, v83
  v_mul_f32 v59, v93, v82
  v_fma_f32 v94, v92, v82, -v58
  v_fma_f32 v95, v92, v83, v59
  v_mul_f32 v74, v107, v83
  v_mul_f32 v75, v107, v82
  v_fma_f32 v108, v106, v82, -v74
  v_fma_f32 v109, v106, v83, v75
  v_cvt_pk_bf16_f32 v72, v94, -v95
  ds_write_b32 v56, v72 offset:20592
  v_cvt_pk_bf16_f32 v72, v108, -v109
  ds_write_b32 v56, v72 offset:24288
  v_mul_f32 v74, v109, v83
  v_mul_f32 v75, v109, v82
  v_fma_f32 v110, v108, v82, -v74
  v_fma_f32 v111, v108, v83, v75
  v_cvt_pk_bf16_f32 v72, v110, -v111
  ds_write_b32 v56, v72 offset:24816
  v_cvt_pk_bf16_f32 v72, v76, -v77
  ds_write_b32 v56, v72 offset:25344
  v_cvt_pk_bf16_f32 v72, v78, -v79
  ds_write_b32 v56, v72 offset:27456
  v_mul_f32 v58, v77, v89
  v_mul_f32 v59, v77, v88
  v_fma_f32 v60, v76, v88, -v58
  v_fma_f32 v61, v76, v89, v59
  v_cvt_pk_bf16_f32 v72, v60, -v61
  ds_write_b32 v56, v72 offset:25872
  v_mul_f32 v58, v77, v97
  v_mul_f32 v59, v77, v96
  v_fma_f32 v60, v76, v96, -v58
  v_fma_f32 v61, v76, v97, v59
  v_cvt_pk_bf16_f32 v72, v60, -v61
  ds_write_b32 v56, v72 offset:26400
  v_mul_f32 v58, v77, v105
  v_mul_f32 v59, v77, v104
  v_fma_f32 v60, v76, v104, -v58
  v_fma_f32 v61, v76, v105, v59
  v_cvt_pk_bf16_f32 v72, v60, -v61
  ds_write_b32 v56, v72 offset:26928
  v_mul_f32 v58, v79, v97
  v_mul_f32 v59, v79, v96
  v_fma_f32 v60, v78, v96, -v58
  v_fma_f32 v61, v78, v97, v59
  v_cvt_pk_bf16_f32 v72, v60, -v61
  ds_write_b32 v56, v72 offset:28512
  v_mul_f32 v58, v77, v79
  v_mul_f32 v59, v77, v78
  v_fma_f32 v62, v76, v78, -v58
  v_fma_f32 v63, v76, v79, v59
  v_cvt_pk_bf16_f32 v72, v62, -v63
  ds_write_b32 v56, v72 offset:29568
  v_mul_f32 v58, v63, v97
  v_mul_f32 v59, v63, v96
  v_fma_f32 v60, v62, v96, -v58
  v_fma_f32 v61, v62, v97, v59
  v_cvt_pk_bf16_f32 v72, v60, -v61
  ds_write_b32 v56, v72 offset:30624
  v_mul_f32 v58, v79, v79
  v_mul_f32 v59, v79, v78
  v_fma_f32 v60, v78, v78, -v58
  v_fma_f32 v61, v78, v79, v59
  v_cvt_pk_bf16_f32 v72, v60, -v61
  ds_write_b32 v56, v72 offset:31680
  v_mul_u32_u24 v54, 528, v52
  v_and_b32 v55, 1, v53
  v_lshl_add_u32 v54, v55, 8, v54
  v_lshrrev_b32 v55, 1, v53
  v_lshl_add_u32 v54, v55, 7, v54
  s_lshr_b32 s28, s3, 1
  s_and_b32 s29, s3, 1
  s_mul_i32 s27, s28, 33792
  s_add_u32 s27, s27, 80896
  s_mul_i32 s30, s29, 8448
  s_add_u32 s30, s30, s27
  v_add_u32 v55, s30, v54
  s_add_u32 s30, s27, 16896
  v_add_u32 v54, s30, v54
  s_waitcnt lgkmcnt(0)
  v_mov_b32 v180, 163812
  v_mov_b32 v181, 1
  s_mov_b64 exec, 1
  ds_add_u32 v180, v181
  s_mov_b64 exec, -1
KG_S1:
  s_sleep 1
  ds_read_b32 v181, v180
  s_waitcnt lgkmcnt(0)
  v_readfirstlane_b32 s43, v181
  s_cmp_lt_u32 s43, 4
  s_cbranch_scc1 KG_S1
  ds_read_b128 v[56:59], v55 offset:0
  ds_read_b128 v[60:63], v54 offset:0
  ds_read_b128 v[64:67], v54 offset:8448
  ds_read_b128 v[68:71], v55 offset:16
  ds_read_b128 v[72:75], v54 offset:16
  ds_read_b128 v[76:79], v54 offset:8464
  ds_read_b128 v[80:83], v55 offset:32
  ds_read_b128 v[84:87], v54 offset:32
  ds_read_b128 v[88:91], v54 offset:8480
  ds_read_b128 v[92:95], v55 offset:48
  ds_read_b128 v[96:99], v54 offset:48
  ds_read_b128 v[100:103], v54 offset:8496
  s_waitcnt lgkmcnt(0)
  v_mfma_f32_16x16x32_bf16 v[24:27], v[60:63], v[56:59], 0
  v_mfma_f32_16x16x32_bf16 v[28:31], v[64:67], v[56:59], 0
  v_mfma_f32_16x16x32_bf16 v[24:27], v[72:75], v[68:71], v[24:27]
  v_mfma_f32_16x16x32_bf16 v[28:31], v[76:79], v[68:71], v[28:31]
  v_mfma_f32_16x16x32_bf16 v[24:27], v[84:87], v[80:83], v[24:27]
  v_mfma_f32_16x16x32_bf16 v[28:31], v[88:91], v[80:83], v[28:31]
  v_mfma_f32_16x16x32_bf16 v[24:27], v[96:99], v[92:95], v[24:27]
  v_mfma_f32_16x16x32_bf16 v[28:31], v[100:103], v[92:95], v[28:31]
  ds_read_b128 v[56:59], v55 offset:64
  ds_read_b128 v[60:63], v54 offset:64
  ds_read_b128 v[64:67], v54 offset:8512
  ds_read_b128 v[68:71], v55 offset:80
  ds_read_b128 v[72:75], v54 offset:80
  ds_read_b128 v[76:79], v54 offset:8528
  ds_read_b128 v[80:83], v55 offset:96
  ds_read_b128 v[84:87], v54 offset:96
  ds_read_b128 v[88:91], v54 offset:8544
  ds_read_b128 v[92:95], v55 offset:112
  ds_read_b128 v[96:99], v54 offset:112
  ds_read_b128 v[100:103], v54 offset:8560
  s_waitcnt lgkmcnt(0)
  v_mfma_f32_16x16x32_bf16 v[24:27], v[60:63], v[56:59], v[24:27]
  v_mfma_f32_16x16x32_bf16 v[28:31], v[64:67], v[56:59], v[28:31]
  v_mfma_f32_16x16x32_bf16 v[24:27], v[72:75], v[68:71], v[24:27]
  v_mfma_f32_16x16x32_bf16 v[28:31], v[76:79], v[68:71], v[28:31]
  v_mfma_f32_16x16x32_bf16 v[24:27], v[84:87], v[80:83], v[24:27]
  v_mfma_f32_16x16x32_bf16 v[28:31], v[88:91], v[80:83], v[28:31]
  v_mfma_f32_16x16x32_bf16 v[24:27], v[96:99], v[92:95], v[24:27]
  v_mfma_f32_16x16x32_bf16 v[28:31], v[100:103], v[92:95], v[28:31]
  s_lshl_b32 s27, s28, 11
  s_lshl_b32 s30, s29, 10
  s_add_u32 s27, s27, s30
  s_add_u32 s27, s27, 76800
  v_lshl_add_u32 v54, v52, 6, s27
  v_lshl_add_u32 v54, v53, 3, v54
  s_nop 0
  v_cvt_pk_bf16_f32 v32, v24, v25
  v_cvt_pk_bf16_f32 v33, v26, v27
  ds_write_b64 v54, v[32:33] offset:0
  v_cvt_pk_bf16_f32 v32, v28, v29
  v_cvt_pk_bf16_f32 v33, v30, v31
  ds_write_b64 v54, v[32:33] offset:32
  v_and_b32 v54, 3, v3
  v_mul_u32_u24 v54, 1280, v54
  v_lshrrev_b32 v55, 2, v3
  v_lshl_add_u32 v54, v55, 4, v54
  v_add_u32 v54, 66816, v54
  s_waitcnt lgkmcnt(0)
  v_mov_b32 v180, 163816
  v_mov_b32 v181, 1
  s_mov_b64 exec, 1
  ds_add_u32 v180, v181
  s_mov_b64 exec, -1
KG_S2:
  s_sleep 1
  ds_read_b32 v181, v180
  s_waitcnt lgkmcnt(0)
  v_readfirstlane_b32 s43, v181
  s_cmp_lt_u32 s43, 4
  s_cbranch_scc1 KG_S2
  ds_read_u16 v28, v44 offset:0
  ds_read_u16 v29, v45 offset:0
  ds_read_u16 v30, v46 offset:0
  ds_read_u16 v31, v47 offset:0
  ds_read_u16 v32, v48 offset:0
  ds_read_u16 v33, v49 offset:0
  ds_read_u16 v34, v50 offset:0
  ds_read_u16 v35, v51 offset:0
  s_waitcnt lgkmcnt(0)
  v_lshl_or_b32 v24, v29, 16, v28
  v_lshl_or_b32 v25, v31, 16, v30
  v_lshl_or_b32 v26, v33, 16, v32
  v_lshl_or_b32 v27, v35, 16, v34
  ds_write_b128 v54, v[24:27] offset:0
  ds_read_u16 v28, v44 offset:2048
  ds_read_u16 v29, v45 offset:2048
  ds_read_u16 v30, v46 offset:2048
  ds_read_u16 v31, v47 offset:2048
  ds_read_u16 v32, v48 offset:2048
  ds_read_u16 v33, v49 offset:2048
  ds_read_u16 v34, v50 offset:2048
  ds_read_u16 v35, v51 offset:2048
  s_waitcnt lgkmcnt(0)
  v_lshl_or_b32 v24, v29, 16, v28
  v_lshl_or_b32 v25, v31, 16, v30
  v_lshl_or_b32 v26, v33, 16, v32
  v_lshl_or_b32 v27, v35, 16, v34
  ds_write_b128 v54, v[24:27] offset:5120
  s_lshr_b32 s27, s2, 3
  s_lshl_b32 s27, s27, 2
  s_add_u32 s27, s27, s3
  s_mul_i32 s27, s27, 14336
  s_and_b32 s30, s2, 3
  s_mul_i32 s30, s30, 896
  s_add_u32 s27, s27, s30
  v_min_u32 v56, 55, v1
  v_lshl_add_u32 v56, v56, 4, s27
  v_add_u32 v57, 7168, v56
  global_load_dwordx4 v[60:63], v56, s[56:57]
  global_load_dwordx4 v[64:67], v56, s[56:57] offset:3584
  global_load_dwordx4 v[68:71], v57, s[56:57]
  global_load_dwordx4 v[72:75], v57, s[56:57] offset:3584
KG_END:
  s_and_b32 s28, s3, 3
  v_sub_u32 v42, 7, v52
  v_and_b32 v42, 7, v42
  v_mul_u32_u24 v42, 4160, v42
  v_sub_u32 v43, 2047, v52
  v_lshrrev_b32 v43, 3, v43
  v_add_u32 v43, v43, v53
  v_lshl_add_u32 v42, v43, 4, v42
  s_mul_i32 s27, s25, 33280
  s_lshl_b32 s30, s28, 8
  s_sub_u32 s27, s27, s30
  s_add_u32 s27, s27, 4294964000
  v_add_u32 v42, s27, v42
  v_mul_u32_u24 v43, 1280, v53
  v_lshl_add_u32 v43, v52, 4, v43
  s_mul_i32 s27, s25, 5120
  s_lshl_b32 s30, s28, 6
  s_sub_u32 s27, s27, s30
  s_add_u32 s27, s27, 66768
  v_add_u32 v43, s27, v43
  s_lshl_b32 s26, s2, 1
  s_add_u32 s26, s26, s25
  s_lshl_b32 s27, s26, 12
  v_lshl_add_u32 v6, v3, 4, s27
  v_lshlrev_b32 v7, 6, v3
  v_add_u32 v7, 0x1300000, v7
  s_lshl_b32 s27, s26, 2
  s_add_u32 s27, s27, 0x1310800
  v_mov_b32 v8, s27
  v_lshrrev_b32 v9, 5, v0
  v_bfe_u32 v10, v1, 3, 2
  v_lshlrev_b32 v11, 7, v9
  v_lshl_add_u32 v11, v10, 4, v11
  v_add_u32 v11, 0x1311800, v11
  s_mul_i32 s27, s25, 33280
  s_add_u32 s27, s27, 4080
  v_lshlrev_b32 v41, 4, v3
  v_sub_u32 v41, s27, v41
  v_lshrrev_b32 v232, 5, v0
  v_bfe_u32 v233, v1, 3, 2
  v_lshlrev_b32 v234, 5, v232
  v_lshl_add_u32 v234, v233, 2, v234
  v_and_b32 v235, 7, v1
  v_mul_u32_u24 v236, 3584, v234
  v_lshl_add_u32 v236, v235, 2, v236
  s_lshl_b32 s28, s33, 5
  v_add_u32 v236, s28, v236
  s_cmp_lg_u32 s3, 0
  s_cbranch_scc1 S1_W
  v_mov_b32 v176, 163824
S1_TAG:
  ds_read_b64 v[178:179], v176
  s_waitcnt lgkmcnt(0)
  v_readfirstlane_b32 s40, v178
  v_readfirstlane_b32 s41, v179
  s_cmp_lg_u32 s40, 0
  s_cbranch_scc1 S1_TAG_D
  s_sleep 2
  s_branch S1_TAG
S1_TAG_D:
  s_bfe_u32 s47, s2, 0x40003
  s_lshl_b32 s47, s47, 11
  v_lshl_add_u32 v187, v1, 4, s47
  v_add_u32 v187, 0x1330000, v187
  s_mov_b32 s42, 0
  s_mov_b64 exec, -1
S1_P:
  s_sleep 8
  global_load_dwordx4 v[176:179], v187, s[4:5] offset:0 sc1
  global_load_dwordx4 v[180:183], v187, s[4:5] offset:1024 sc1
  s_waitcnt vmcnt(0)
  v_xor_b32 v176, s40, v176
  v_xor_b32 v177, s41, v177
  v_xor_b32 v178, s40, v178
  v_xor_b32 v179, s41, v179
  v_xor_b32 v180, s40, v180
  v_xor_b32 v181, s41, v181
  v_xor_b32 v182, s40, v182
  v_xor_b32 v183, s41, v183
  v_or_b32 v176, v176, v177
  v_or_b32 v176, v176, v178
  v_or_b32 v176, v176, v179
  v_or_b32 v176, v176, v180
  v_or_b32 v176, v176, v181
  v_or_b32 v176, v176, v182
  v_or_b32 v176, v176, v183
  v_cmp_ne_u32 vcc, 0, v176
  s_add_u32 s42, s42, 1
  s_cmp_gt_u32 s42, 0x40000
  s_cbranch_scc1 S1_P_D
  s_nop 2
  s_cbranch_vccnz S1_P
S1_P_D:
  s_mov_b64 exec, -1
S1_W:
  s_barrier
  s_waitcnt vmcnt(0)
  global_load_dwordx4 v[20:23], v6, s[4:5]
  global_load_dwordx4 v[24:27], v7, s[4:5] offset:0
  global_load_dwordx4 v[28:31], v7, s[4:5] offset:16
  global_load_dwordx4 v[32:35], v7, s[4:5] offset:32
  global_load_dwordx4 v[36:39], v7, s[4:5] offset:48
  global_load_dword v17, v8, s[4:5] offset:-2048
  global_load_dword v18, v8, s[4:5]
  global_load_dword v19, v8, s[4:5] offset:2048
  global_load_dwordx4 v[200:203], v11, s[4:5]
  global_load_dwordx4 v[204:207], v11, s[4:5] offset:64
  global_load_dwordx4 v[208:211], v11, s[4:5] offset:2048
  global_load_dwordx4 v[212:215], v11, s[4:5] offset:2112
  s_mul_i32 s27, s33, 0x2493
  s_lshr_b32 s27, s27, 16
  s_mul_i32 s28, s27, 7
  s_sub_u32 s28, s33, s28
  s_mul_i32 s27, s27, 224
  s_mul_i32 s29, s32, 7
  s_add_u32 s27, s27, s29
  s_add_u32 s27, s27, s28
  s_lshl_b32 s27, s27, 10
  s_add_u32 s27, s27, 0x600000
  v_mul_u32_u24 v12, 14336, v9
  v_lshl_add_u32 v12, v10, 8, v12
  v_and_b32 v13, 7, v1
  v_lshl_add_u32 v12, v13, 4, v12
  v_add_u32 v12, s27, v12
  s_cmp_ge_u32 s2, 224
  s_cselect_b32 s27, 0x4000000, 0
  v_add_u32 v12, s27, v12
  v_lshlrev_b32 v40, 16, v127
  s_waitcnt vmcnt(4)
  v_add_f32 v18, 1.0, v18
  v_cvt_pk_bf16_f32 v18, v18, v18
  v_lshlrev_b32 v18, 16, v18
  v_lshlrev_b32 v60, 16, v20
  v_and_b32 v61, 0xffff0000, v20
  v_sub_f32 v60, v60, v24
  v_sub_f32 v61, v61, v26
  v_mul_f32 v60, v60, v25
  v_mul_f32 v61, v61, v27
  v_fma_f32 v60, v60, v18, v17
  v_fma_f32 v61, v61, v18, v17
  v_cvt_pk_bf16_f32 v71, v61, v60
  v_lshlrev_b32 v62, 16, v21
  v_and_b32 v63, 0xffff0000, v21
  v_sub_f32 v62, v62, v28
  v_sub_f32 v63, v63, v30
  v_mul_f32 v62, v62, v29
  v_mul_f32 v63, v63, v31
  v_fma_f32 v62, v62, v18, v17
  v_fma_f32 v63, v63, v18, v17
  v_cvt_pk_bf16_f32 v70, v63, v62
  v_lshlrev_b32 v64, 16, v22
  v_and_b32 v65, 0xffff0000, v22
  v_sub_f32 v64, v64, v32
  v_sub_f32 v65, v65, v34
  v_mul_f32 v64, v64, v33
  v_mul_f32 v65, v65, v35
  v_fma_f32 v64, v64, v18, v17
  v_fma_f32 v65, v65, v18, v17
  v_cvt_pk_bf16_f32 v69, v65, v64
  v_lshlrev_b32 v66, 16, v23
  v_and_b32 v67, 0xffff0000, v23
  v_sub_f32 v66, v66, v36
  v_sub_f32 v67, v67, v38
  v_mul_f32 v66, v66, v37
  v_mul_f32 v67, v67, v39
  v_fma_f32 v66, v66, v18, v17
  v_fma_f32 v67, v67, v18, v17
  v_cvt_pk_bf16_f32 v68, v67, v66
  ds_write_b128 v41, v[68:71]
  s_waitcnt lgkmcnt(0)
  s_barrier
  ds_read_b128 v[72:75], v41 offset:16
  v_and_b32 v60, 0xffff0000, v71
  v_lshlrev_b32 v61, 16, v71
  v_and_b32 v62, 0xffff0000, v70
  v_lshlrev_b32 v63, 16, v70
  v_and_b32 v64, 0xffff0000, v69
  v_lshlrev_b32 v65, 16, v69
  v_and_b32 v66, 0xffff0000, v68
  v_lshlrev_b32 v67, 16, v68
  v_mov_b32 v76, v69
  v_alignbit_b32 v82, v69, v68, 16
  v_mov_b32 v77, v70
  v_alignbit_b32 v83, v70, v69, 16
  v_mov_b32 v78, v71
  v_alignbit_b32 v84, v71, v70, 16
  v_alignbit_b32 v88, v70, v69, 16
  v_alignbit_b32 v89, v71, v70, 16
  s_waitcnt lgkmcnt(0)
  v_mov_b32 v79, v72
  v_alignbit_b32 v85, v72, v71, 16
  v_mov_b32 v80, v73
  v_alignbit_b32 v86, v73, v72, 16
  v_mov_b32 v81, v74
  v_alignbit_b32 v87, v74, v73, 16
  v_alignbit_b32 v90, v72, v71, 16
  v_alignbit_b32 v91, v73, v72, 16
  v_alignbit_b32 v92, v74, v73, 16
  v_alignbit_b32 v93, v75, v74, 16
  ds_write_b128 v41, v[70:73] offset:16640
  ds_write_b128 v41, v[82:85] offset:4160
  ds_write_b128 v41, v[76:79] offset:8320
  ds_write_b128 v41, v[88:91] offset:12480
  ds_write_b128 v41, v[84:87] offset:20800
  ds_write_b128 v41, v[78:81] offset:24960
  ds_write_b128 v41, v[90:93] offset:29120
  v_add_u32 v237, 0, v236
  global_load_dword v192, v237, s[56:57]
  v_add_u32 v237, 3584, v236
  global_load_dword v193, v237, s[56:57]
  v_add_u32 v237, 7168, v236
  global_load_dword v194, v237, s[56:57]
  v_add_u32 v237, 10752, v236
  global_load_dword v195, v237, s[56:57]
  v_add_u32 v237, 57344, v236
  global_load_dword v196, v237, s[56:57]
  v_add_u32 v237, 60928, v236
  global_load_dword v197, v237, s[56:57]
  v_add_u32 v237, 64512, v236
  global_load_dword v198, v237, s[56:57]
  v_add_u32 v237, 68096, v236
  global_load_dword v199, v237, s[56:57]
  s_waitcnt lgkmcnt(0)
  s_barrier
  ds_read_b128 v[100:103], v43 offset:48
  ds_read_b128 v[104:107], v43 offset:304
  ds_read_b128 v[108:111], v43 offset:560
  ds_read_b128 v[112:115], v43 offset:816
  ds_read_b128 v[116:119], v42 offset:3296
  ds_read_b128 v[120:123], v42 offset:3264
  ds_read_b128 v[124:127], v42 offset:2272
  ds_read_b128 v[128:131], v42 offset:2240
  ds_read_b128 v[132:135], v42 offset:1248
  ds_read_b128 v[136:139], v42 offset:1216
  ds_read_b128 v[140:143], v42 offset:224
  ds_read_b128 v[144:147], v42 offset:192
  s_waitcnt lgkmcnt(0)
  v_mfma_f32_16x16x32_bf16 v[68:71], v[116:119], v[100:103], 0
  ds_read_b128 v[148:151], v43 offset:32
  v_mfma_f32_16x16x32_bf16 v[72:75], v[120:123], v[100:103], 0
  ds_read_b128 v[152:155], v43 offset:288
  v_mfma_f32_16x16x32_bf16 v[76:79], v[116:119], v[104:107], 0
  ds_read_b128 v[156:159], v43 offset:544
  v_mfma_f32_16x16x32_bf16 v[80:83], v[120:123], v[104:107], 0
  ds_read_b128 v[160:163], v43 offset:800
  v_mfma_f32_16x16x32_bf16 v[84:87], v[116:119], v[108:111], 0
  ds_read_b128 v[164:167], v42 offset:3232
  v_mfma_f32_16x16x32_bf16 v[88:91], v[120:123], v[108:111], 0
  ds_read_b128 v[24:27], v42 offset:3200
  v_mfma_f32_16x16x32_bf16 v[92:95], v[116:119], v[112:115], 0
  ds_read_b128 v[28:31], v42 offset:2208
  v_mfma_f32_16x16x32_bf16 v[96:99], v[120:123], v[112:115], 0
  ds_read_b128 v[32:35], v42 offset:2176
  v_mfma_f32_16x16x32_bf16 v[76:79], v[124:127], v[100:103], v[76:79]
  ds_read_b128 v[36:39], v42 offset:1184
  v_mfma_f32_16x16x32_bf16 v[80:83], v[128:131], v[100:103], v[80:83]
  ds_read_b128 v[44:47], v42 offset:1152
  v_mfma_f32_16x16x32_bf16 v[84:87], v[124:127], v[104:107], v[84:87]
  ds_read_b128 v[48:51], v42 offset:160
  v_mfma_f32_16x16x32_bf16 v[88:91], v[128:131], v[104:107], v[88:91]
  ds_read_b128 v[56:59], v42 offset:128
  v_mfma_f32_16x16x32_bf16 v[92:95], v[124:127], v[108:111], v[92:95]
  v_mfma_f32_16x16x32_bf16 v[96:99], v[128:131], v[108:111], v[96:99]
  v_mfma_f32_16x16x32_bf16 v[84:87], v[132:135], v[100:103], v[84:87]
  v_mfma_f32_16x16x32_bf16 v[88:91], v[136:139], v[100:103], v[88:91]
  v_mfma_f32_16x16x32_bf16 v[92:95], v[132:135], v[104:107], v[92:95]
  v_mfma_f32_16x16x32_bf16 v[96:99], v[136:139], v[104:107], v[96:99]
  v_mfma_f32_16x16x32_bf16 v[92:95], v[140:143], v[100:103], v[92:95]
  v_mfma_f32_16x16x32_bf16 v[96:99], v[144:147], v[100:103], v[96:99]
  s_waitcnt lgkmcnt(0)
  v_mfma_f32_16x16x32_bf16 v[68:71], v[164:167], v[148:151], v[68:71]
  ds_read_b128 v[100:103], v43 offset:16
  s_waitcnt vmcnt(0)
  v_add_f32 v208, 1.0, v208
  v_cvt_pk_bf16_f32 v208, v208, v208
  v_lshlrev_b32 v208, 16, v208
  v_mfma_f32_16x16x32_bf16 v[72:75], v[24:27], v[148:151], v[72:75]
  ds_read_b128 v[104:107], v43 offset:272
  v_add_f32 v209, 1.0, v209
  v_cvt_pk_bf16_f32 v209, v209, v209
  v_lshlrev_b32 v209, 16, v209
  v_add_f32 v210, 1.0, v210
  v_mfma_f32_16x16x32_bf16 v[76:79], v[164:167], v[152:155], v[76:79]
  ds_read_b128 v[108:111], v43 offset:528
  v_cvt_pk_bf16_f32 v210, v210, v210
  v_lshlrev_b32 v210, 16, v210
  v_add_f32 v211, 1.0, v211
  v_cvt_pk_bf16_f32 v211, v211, v211
  v_mfma_f32_16x16x32_bf16 v[80:83], v[24:27], v[152:155], v[80:83]
  ds_read_b128 v[112:115], v43 offset:784
  v_lshlrev_b32 v211, 16, v211
  v_add_f32 v212, 1.0, v212
  v_cvt_pk_bf16_f32 v212, v212, v212
  v_lshlrev_b32 v212, 16, v212
  v_mfma_f32_16x16x32_bf16 v[84:87], v[164:167], v[156:159], v[84:87]
  ds_read_b128 v[116:119], v42 offset:3168
  v_add_f32 v213, 1.0, v213
  v_cvt_pk_bf16_f32 v213, v213, v213
  v_lshlrev_b32 v213, 16, v213
  v_add_f32 v214, 1.0, v214
  v_mfma_f32_16x16x32_bf16 v[88:91], v[24:27], v[156:159], v[88:91]
  ds_read_b128 v[120:123], v42 offset:3136
  v_cvt_pk_bf16_f32 v214, v214, v214
  v_lshlrev_b32 v214, 16, v214
  v_add_f32 v215, 1.0, v215
  v_cvt_pk_bf16_f32 v215, v215, v215
  v_mfma_f32_16x16x32_bf16 v[92:95], v[164:167], v[160:163], v[92:95]
  ds_read_b128 v[124:127], v42 offset:2144
  v_lshlrev_b32 v215, 16, v215
  v_mov_b32 v224, 0
  v_mov_b32 v225, 0
  v_mov_b32 v226, 0
  v_mfma_f32_16x16x32_bf16 v[96:99], v[24:27], v[160:163], v[96:99]
  ds_read_b128 v[128:131], v42 offset:2112
  v_mov_b32 v227, 0
  v_lshlrev_b32 v228, 16, v192
  v_and_b32 v229, 0xffff0000, v192
  v_lshlrev_b32 v230, 16, v193
  v_mfma_f32_16x16x32_bf16 v[76:79], v[28:31], v[148:151], v[76:79]
  ds_read_b128 v[132:135], v42 offset:1120
  v_and_b32 v231, 0xffff0000, v193
  v_fmac_f32 v226, v228, v200
  v_fmac_f32 v227, v229, v200
  v_fmac_f32 v226, v230, v201
  v_mfma_f32_16x16x32_bf16 v[80:83], v[32:35], v[148:151], v[80:83]
  ds_read_b128 v[136:139], v42 offset:1088
  v_fmac_f32 v227, v231, v201
  v_mul_f32 v228, v228, v208
  v_mul_f32 v229, v229, v208
  v_mul_f32 v230, v230, v209
  v_mfma_f32_16x16x32_bf16 v[84:87], v[28:31], v[152:155], v[84:87]
  ds_read_b128 v[140:143], v42 offset:96
  v_mul_f32 v231, v231, v209
  v_cvt_pk_bf16_f32 v216, v228, v230
  v_cvt_pk_bf16_f32 v220, v229, v231
  v_lshlrev_b32 v228, 16, v216
  v_mfma_f32_16x16x32_bf16 v[88:91], v[32:35], v[152:155], v[88:91]
  ds_read_b128 v[144:147], v42 offset:64
  v_and_b32 v229, 0xffff0000, v216
  v_add_f32 v224, v224, v228
  v_add_f32 v224, v224, v229
  v_lshlrev_b32 v228, 16, v220
  v_mfma_f32_16x16x32_bf16 v[92:95], v[28:31], v[156:159], v[92:95]
  v_and_b32 v229, 0xffff0000, v220
  v_add_f32 v225, v225, v228
  v_add_f32 v225, v225, v229
  v_lshlrev_b32 v228, 16, v194
  v_mfma_f32_16x16x32_bf16 v[96:99], v[32:35], v[156:159], v[96:99]
  v_and_b32 v229, 0xffff0000, v194
  v_lshlrev_b32 v230, 16, v195
  v_and_b32 v231, 0xffff0000, v195
  v_fmac_f32 v226, v228, v202
  v_mfma_f32_16x16x32_bf16 v[84:87], v[36:39], v[148:151], v[84:87]
  v_fmac_f32 v227, v229, v202
  v_fmac_f32 v226, v230, v203
  v_fmac_f32 v227, v231, v203
  v_mul_f32 v228, v228, v210
  v_mfma_f32_16x16x32_bf16 v[88:91], v[44:47], v[148:151], v[88:91]
  v_mul_f32 v229, v229, v210
  v_mul_f32 v230, v230, v211
  v_mul_f32 v231, v231, v211
  v_cvt_pk_bf16_f32 v217, v228, v230
  v_mfma_f32_16x16x32_bf16 v[92:95], v[36:39], v[152:155], v[92:95]
  v_cvt_pk_bf16_f32 v221, v229, v231
  v_lshlrev_b32 v228, 16, v217
  v_and_b32 v229, 0xffff0000, v217
  v_add_f32 v224, v224, v228
  v_mfma_f32_16x16x32_bf16 v[96:99], v[44:47], v[152:155], v[96:99]
  v_add_f32 v224, v224, v229
  v_lshlrev_b32 v228, 16, v221
  v_and_b32 v229, 0xffff0000, v221
  v_add_f32 v225, v225, v228
  v_mfma_f32_16x16x32_bf16 v[92:95], v[48:51], v[148:151], v[92:95]
  v_add_f32 v225, v225, v229
  v_lshlrev_b32 v228, 16, v196
  v_and_b32 v229, 0xffff0000, v196
  v_lshlrev_b32 v230, 16, v197
  v_mfma_f32_16x16x32_bf16 v[96:99], v[56:59], v[148:151], v[96:99]
  v_and_b32 v231, 0xffff0000, v197
  v_fmac_f32 v226, v228, v204
  v_fmac_f32 v227, v229, v204
  v_fmac_f32 v226, v230, v205
  s_waitcnt lgkmcnt(0)
  v_mfma_f32_16x16x32_bf16 v[68:71], v[116:119], v[100:103], v[68:71]
  ds_read_b128 v[148:151], v43 offset:0
  v_fmac_f32 v227, v231, v205
  v_mul_f32 v228, v228, v212
  v_mul_f32 v229, v229, v212
  v_mul_f32 v230, v230, v213
  v_mfma_f32_16x16x32_bf16 v[72:75], v[120:123], v[100:103], v[72:75]
  ds_read_b128 v[152:155], v43 offset:256
  v_mul_f32 v231, v231, v213
  v_cvt_pk_bf16_f32 v218, v228, v230
  v_cvt_pk_bf16_f32 v222, v229, v231
  v_lshlrev_b32 v228, 16, v218
  v_mfma_f32_16x16x32_bf16 v[76:79], v[116:119], v[104:107], v[76:79]
  ds_read_b128 v[156:159], v43 offset:512
  v_and_b32 v229, 0xffff0000, v218
  v_add_f32 v224, v224, v228
  v_add_f32 v224, v224, v229
  v_lshlrev_b32 v228, 16, v222
  v_mfma_f32_16x16x32_bf16 v[80:83], v[120:123], v[104:107], v[80:83]
  ds_read_b128 v[160:163], v43 offset:768
  v_and_b32 v229, 0xffff0000, v222
  v_add_f32 v225, v225, v228
  v_add_f32 v225, v225, v229
  v_lshlrev_b32 v228, 16, v198
  v_mfma_f32_16x16x32_bf16 v[84:87], v[116:119], v[108:111], v[84:87]
  ds_read_b128 v[164:167], v42 offset:3104
  v_and_b32 v229, 0xffff0000, v198
  v_lshlrev_b32 v230, 16, v199
  v_and_b32 v231, 0xffff0000, v199
  v_fmac_f32 v226, v228, v206
  v_mfma_f32_16x16x32_bf16 v[88:91], v[120:123], v[108:111], v[88:91]
  ds_read_b128 v[24:27], v42 offset:3072
  v_fmac_f32 v227, v229, v206
  v_fmac_f32 v226, v230, v207
  v_fmac_f32 v227, v231, v207
  v_mul_f32 v228, v228, v214
  v_mfma_f32_16x16x32_bf16 v[92:95], v[116:119], v[112:115], v[92:95]
  ds_read_b128 v[28:31], v42 offset:2080
  v_mul_f32 v229, v229, v214
  v_mul_f32 v230, v230, v215
  v_mul_f32 v231, v231, v215
  v_cvt_pk_bf16_f32 v219, v228, v230
  v_mfma_f32_16x16x32_bf16 v[96:99], v[120:123], v[112:115], v[96:99]
  ds_read_b128 v[32:35], v42 offset:2048
  v_cvt_pk_bf16_f32 v223, v229, v231
  v_lshlrev_b32 v228, 16, v219
  v_and_b32 v229, 0xffff0000, v219
  v_add_f32 v224, v224, v228
  v_mfma_f32_16x16x32_bf16 v[76:79], v[124:127], v[100:103], v[76:79]
  ds_read_b128 v[36:39], v42 offset:1056
  v_add_f32 v224, v224, v229
  v_lshlrev_b32 v228, 16, v223
  v_and_b32 v229, 0xffff0000, v223
  v_add_f32 v225, v225, v228
  v_mfma_f32_16x16x32_bf16 v[80:83], v[128:131], v[100:103], v[80:83]
  ds_read_b128 v[44:47], v42 offset:1024
  v_add_f32 v225, v225, v229
  buffer_store_dwordx4 v[216:219], v12, s[36:39], 0 offen sc1
  buffer_store_dwordx4 v[220:223], v12, s[36:39], 0 offen offset:128 sc1
  v_permlane32_swap_b32 v224, v226
  v_mfma_f32_16x16x32_bf16 v[84:87], v[124:127], v[104:107], v[84:87]
  ds_read_b128 v[48:51], v42 offset:32
  v_permlane32_swap_b32 v225, v227
  v_add_f32 v224, v224, v226
  v_add_f32 v225, v225, v227
  s_nop 1
  v_permlane16_swap_b32 v224, v225
  v_mfma_f32_16x16x32_bf16 v[88:91], v[128:131], v[104:107], v[88:91]
  ds_read_b128 v[56:59], v42 offset:0
  v_add_f32 v224, v224, v225
  s_nop 1
  v_add_f32_dpp v224, v224, v224 row_ror:8 row_mask:0xf bank_mask:0xf
  v_lshrrev_b32 v228, 5, v1
  v_lshlrev_b32 v228, 6, v228
  v_mfma_f32_16x16x32_bf16 v[92:95], v[124:127], v[108:111], v[92:95]
  v_lshl_add_u32 v228, v13, 2, v228
  v_bfe_u32 v229, v1, 4, 1
  v_lshl_add_u32 v228, v229, 5, v228
  s_lshl_b32 s27, s3, 7
  v_mfma_f32_16x16x32_bf16 v[96:99], v[128:131], v[108:111], v[96:99]
  s_add_u32 s27, s27, 154624
  v_add_u32 v228, s27, v228
  v_mfma_f32_16x16x32_bf16 v[84:87], v[132:135], v[100:103], v[84:87]
  v_mfma_f32_16x16x32_bf16 v[88:91], v[136:139], v[100:103], v[88:91]
  v_mfma_f32_16x16x32_bf16 v[92:95], v[132:135], v[104:107], v[92:95]
  v_mfma_f32_16x16x32_bf16 v[96:99], v[136:139], v[104:107], v[96:99]
  v_mfma_f32_16x16x32_bf16 v[92:95], v[140:143], v[100:103], v[92:95]
  v_mfma_f32_16x16x32_bf16 v[96:99], v[144:147], v[100:103], v[96:99]
  s_waitcnt lgkmcnt(0)
  v_mfma_f32_16x16x32_bf16 v[68:71], v[164:167], v[148:151], v[68:71]
  v_mfma_f32_16x16x32_bf16 v[72:75], v[24:27], v[148:151], v[72:75]
  v_mfma_f32_16x16x32_bf16 v[76:79], v[164:167], v[152:155], v[76:79]
  v_mfma_f32_16x16x32_bf16 v[80:83], v[24:27], v[152:155], v[80:83]
  v_mfma_f32_16x16x32_bf16 v[84:87], v[164:167], v[156:159], v[84:87]
  v_mfma_f32_16x16x32_bf16 v[88:91], v[24:27], v[156:159], v[88:91]
  v_mfma_f32_16x16x32_bf16 v[92:95], v[164:167], v[160:163], v[92:95]
  v_mfma_f32_16x16x32_bf16 v[96:99], v[24:27], v[160:163], v[96:99]
  v_mfma_f32_16x16x32_bf16 v[76:79], v[28:31], v[148:151], v[76:79]
  v_mfma_f32_16x16x32_bf16 v[80:83], v[32:35], v[148:151], v[80:83]
  v_mfma_f32_16x16x32_bf16 v[84:87], v[28:31], v[152:155], v[84:87]
  v_mfma_f32_16x16x32_bf16 v[88:91], v[32:35], v[152:155], v[88:91]
  v_mfma_f32_16x16x32_bf16 v[92:95], v[28:31], v[156:159], v[92:95]
  v_mfma_f32_16x16x32_bf16 v[96:99], v[32:35], v[156:159], v[96:99]
  v_mfma_f32_16x16x32_bf16 v[84:87], v[36:39], v[148:151], v[84:87]
  v_mfma_f32_16x16x32_bf16 v[88:91], v[44:47], v[148:151], v[88:91]
  v_mfma_f32_16x16x32_bf16 v[92:95], v[36:39], v[152:155], v[92:95]
  v_mfma_f32_16x16x32_bf16 v[96:99], v[44:47], v[152:155], v[96:99]
  v_mfma_f32_16x16x32_bf16 v[92:95], v[48:51], v[148:151], v[92:95]
  v_mfma_f32_16x16x32_bf16 v[96:99], v[56:59], v[148:151], v[96:99]
  ds_write_b32 v228, v224
  s_mul_i32 s27, s3, 9216
  s_add_u32 s27, s27, 80896
  v_mul_u32_u24 v54, 144, v52
  v_lshl_add_u32 v54, v53, 4, v54
  v_add_u32 v54, s27, v54
  ds_write_b128 v54, v[68:71] offset:0
  ds_write_b128 v54, v[72:75] offset:64
  ds_write_b128 v54, v[76:79] offset:2304
  ds_write_b128 v54, v[80:83] offset:2368
  ds_write_b128 v54, v[84:87] offset:4608
  ds_write_b128 v54, v[88:91] offset:4672
  ds_write_b128 v54, v[92:95] offset:6912
  ds_write_b128 v54, v[96:99] offset:6976
  s_mul_i32 s27, s25, 36864
  s_add_u32 s27, s27, 80896
  v_lshrrev_b32 v54, 2, v3
  v_mul_u32_u24 v54, 144, v54
  v_and_b32 v55, 3, v3
  v_lshl_add_u32 v54, v55, 5, v54
  v_add_u32 v54, s27, v54
  s_waitcnt lgkmcnt(0)
  s_barrier
  ds_read_b128 v[100:103], v54 offset:0
  ds_read_b128 v[104:107], v54 offset:16
  ds_read_b128 v[108:111], v54 offset:9216
  ds_read_b128 v[112:115], v54 offset:9232
  ds_read_b128 v[116:119], v54 offset:18432
  ds_read_b128 v[120:123], v54 offset:18448
  ds_read_b128 v[124:127], v54 offset:27648
  ds_read_b128 v[128:131], v54 offset:27664
  v_mul_f32 v60, v60, v40
  v_mul_f32 v61, v61, v40
  v_cvt_pk_bf16_f32 v58, v60, v61
  v_lshlrev_b32 v60, 16, v58
  v_and_b32 v61, 0xffff0000, v58
  v_mul_f32 v62, v62, v40
  v_mul_f32 v63, v63, v40
  v_cvt_pk_bf16_f32 v58, v62, v63
  v_lshlrev_b32 v62, 16, v58
  v_and_b32 v63, 0xffff0000, v58
  v_mul_f32 v64, v64, v40
  v_mul_f32 v65, v65, v40
  v_cvt_pk_bf16_f32 v58, v64, v65
  v_lshlrev_b32 v64, 16, v58
  v_and_b32 v65, 0xffff0000, v58
  v_mul_f32 v66, v66, v40
  v_mul_f32 v67, v67, v40
  v_cvt_pk_bf16_f32 v58, v66, v67
  v_lshlrev_b32 v66, 16, v58
  v_and_b32 v67, 0xffff0000, v58
  s_cmp_lg_u32 s3, 7
  s_cbranch_scc1 C_NS
  s_cmp_ge_u32 s2, 224
  s_cbranch_scc1 C_NS
  v_and_b32 v232, 31, v1
  v_lshlrev_b32 v233, 2, v232
  v_add_u32 v233, 154624, v233
  ds_read_b32 v236, v233 offset:0
  ds_read_b32 v237, v233 offset:128
  ds_read_b32 v238, v233 offset:256
  ds_read_b32 v239, v233 offset:384
  ds_read_b32 v240, v233 offset:512
  ds_read_b32 v241, v233 offset:640
  ds_read_b32 v242, v233 offset:768
  ds_read_b32 v243, v233 offset:896
  s_mul_i32 s27, s32, 14336
  s_lshl_b32 s28, s33, 6
  s_add_u32 s27, s27, s28
  s_add_u32 s27, s27, 0x1320000
  v_lshrrev_b32 v233, 4, v232
  v_mul_u32_u24 v233, 7168, v233
  v_and_b32 v232, 15, v232
  v_lshl_add_u32 v233, v232, 2, v233
  v_add_u32 v233, s27, v233
  s_waitcnt lgkmcnt(0)
  v_add_f32 v236, v236, v237
  v_add_f32 v236, v236, v238
  v_add_f32 v236, v236, v239
  v_add_f32 v236, v236, v240
  v_add_f32 v236, v236, v241
  v_add_f32 v236, v236, v242
  v_add_f32 v236, v236, v243
  global_store_dword v233, v236, s[4:5] sc1
C_NS:
  s_waitcnt lgkmcnt(0)
  v_add_f32 v100, v100, v108
  v_add_f32 v116, v116, v124
  v_add_f32 v100, v100, v116
  v_add_f32 v101, v101, v109
  v_add_f32 v117, v117, v125
  v_add_f32 v101, v101, v117
  v_add_f32 v102, v102, v110
  v_add_f32 v118, v118, v126
  v_add_f32 v102, v102, v118
  v_add_f32 v103, v103, v111
  v_add_f32 v119, v119, v127
  v_add_f32 v103, v103, v119
  v_add_f32 v104, v104, v112
  v_add_f32 v120, v120, v128
  v_add_f32 v104, v104, v120
  v_add_f32 v105, v105, v113
  v_add_f32 v121, v121, v129
  v_add_f32 v105, v105, v121
  v_add_f32 v106, v106, v114
  v_add_f32 v122, v122, v130
  v_add_f32 v106, v106, v122
  v_add_f32 v107, v107, v115
  v_add_f32 v123, v123, v131
  v_add_f32 v107, v107, v123
  v_cvt_pk_bf16_f32 v58, v100, v101
  v_lshlrev_b32 v100, 16, v58
  v_and_b32 v101, 0xffff0000, v58
  v_add_f32 v100, v100, v60
  v_add_f32 v101, v101, v61
  v_cvt_pk_bf16_f32 v58, v100, v101
  v_lshlrev_b32 v100, 16, v58
  v_and_b32 v101, 0xffff0000, v58
  v_mul_f32 v100, v100, v19
  v_mul_f32 v101, v101, v19
  v_cvt_pk_bf16_f32 v58, v100, v101
  v_lshlrev_b32 v100, 16, v58
  v_and_b32 v101, 0xffff0000, v58
  v_lshlrev_b32 v60, 16, v20
  v_and_b32 v61, 0xffff0000, v20
  v_add_f32 v100, v100, v60
  v_add_f32 v101, v101, v61
  v_cvt_pk_bf16_f32 v24, v100, v101
  v_cvt_pk_bf16_f32 v58, v102, v103
  v_lshlrev_b32 v102, 16, v58
  v_and_b32 v103, 0xffff0000, v58
  v_add_f32 v102, v102, v62
  v_add_f32 v103, v103, v63
  v_cvt_pk_bf16_f32 v58, v102, v103
  v_lshlrev_b32 v102, 16, v58
  v_and_b32 v103, 0xffff0000, v58
  v_mul_f32 v102, v102, v19
  v_mul_f32 v103, v103, v19
  v_cvt_pk_bf16_f32 v58, v102, v103
  v_lshlrev_b32 v102, 16, v58
  v_and_b32 v103, 0xffff0000, v58
  v_lshlrev_b32 v62, 16, v21
  v_and_b32 v63, 0xffff0000, v21
  v_add_f32 v102, v102, v62
  v_add_f32 v103, v103, v63
  v_cvt_pk_bf16_f32 v25, v102, v103
  v_cvt_pk_bf16_f32 v58, v104, v105
  v_lshlrev_b32 v104, 16, v58
  v_and_b32 v105, 0xffff0000, v58
  v_add_f32 v104, v104, v64
  v_add_f32 v105, v105, v65
  v_cvt_pk_bf16_f32 v58, v104, v105
  v_lshlrev_b32 v104, 16, v58
  v_and_b32 v105, 0xffff0000, v58
  v_mul_f32 v104, v104, v19
  v_mul_f32 v105, v105, v19
  v_cvt_pk_bf16_f32 v58, v104, v105
  v_lshlrev_b32 v104, 16, v58
  v_and_b32 v105, 0xffff0000, v58
  v_lshlrev_b32 v64, 16, v22
  v_and_b32 v65, 0xffff0000, v22
  v_add_f32 v104, v104, v64
  v_add_f32 v105, v105, v65
  v_cvt_pk_bf16_f32 v26, v104, v105
  v_cvt_pk_bf16_f32 v58, v106, v107
  v_lshlrev_b32 v106, 16, v58
  v_and_b32 v107, 0xffff0000, v58
  v_add_f32 v106, v106, v66
  v_add_f32 v107, v107, v67
  v_cvt_pk_bf16_f32 v58, v106, v107
  v_lshlrev_b32 v106, 16, v58
  v_and_b32 v107, 0xffff0000, v58
  v_mul_f32 v106, v106, v19
  v_mul_f32 v107, v107, v19
  v_cvt_pk_bf16_f32 v58, v106, v107
  v_lshlrev_b32 v106, 16, v58
  v_and_b32 v107, 0xffff0000, v58
  v_lshlrev_b32 v66, 16, v23
  v_and_b32 v67, 0xffff0000, v23
  v_add_f32 v106, v106, v66
  v_add_f32 v107, v107, v67
  v_cvt_pk_bf16_f32 v27, v106, v107
  v_add_u32 v6, 0x200000, v6
  global_store_dwordx4 v6, v[24:27], s[4:5] sc1
  s_waitcnt vmcnt(0)
  s_barrier
  s_cmp_lg_u32 s3, 0
  s_cbranch_scc1 S2_W
  s_add_u32 s43, s46, 0x1338000
  v_lshl_add_u32 v176, v1, 11, s43
  v_mov_b32 v178, s40
  v_mov_b32 v179, s41
  s_mov_b64 exec, 0xffff
  global_store_dwordx2 v176, v[178:179], s[4:5] sc1
  s_mov_b64 exec, -1
  v_lshl_add_u32 v187, v1, 4, s47
  v_add_u32 v187, 0x1338000, v187
  s_mov_b32 s42, 0
  s_mov_b64 exec, -1
S2_P:
  s_sleep 8
  global_load_dwordx4 v[176:179], v187, s[4:5] offset:0 sc1
  global_load_dwordx4 v[180:183], v187, s[4:5] offset:1024 sc1
  s_waitcnt vmcnt(0)
  v_xor_b32 v176, s40, v176
  v_xor_b32 v177, s41, v177
  v_xor_b32 v178, s40, v178
  v_xor_b32 v179, s41, v179
  v_xor_b32 v180, s40, v180
  v_xor_b32 v181, s41, v181
  v_xor_b32 v182, s40, v182
  v_xor_b32 v183, s41, v183
  v_or_b32 v176, v176, v177
  v_or_b32 v176, v176, v178
  v_or_b32 v176, v176, v179
  v_or_b32 v176, v176, v180
  v_or_b32 v176, v176, v181
  v_or_b32 v176, v176, v182
  v_or_b32 v176, v176, v183
  v_cmp_ne_u32 vcc, 0, v176
  s_add_u32 s42, s42, 1
  s_cmp_gt_u32 s42, 0x40000
  s_cbranch_scc1 S2_P_D
  s_nop 2
  s_cbranch_vccnz S2_P
S2_P_D:
  s_mov_b64 exec, -1
S2_W:
  s_add_u32 s8, s4, 0x200000
  s_addc_u32 s9, s5, 0
  s_mov_b32 s10, 0x200000
  s_mov_b32 s11, 0x00020000
  s_add_u32 s12, s4, 0x600000
  s_addc_u32 s13, s5, 0
  s_mov_b32 s14, 0x380000
  s_mov_b32 s15, 0x00020000
  v_lshrrev_b32 v2, 6, v0
  v_lshrrev_b32 v3, 4, v1
  v_lshl_add_u32 v4, v2, 3, v3
  v_bfe_u32 v5, v1, 1, 3
  v_xor_b32 v6, v5, v3
  v_xor_b32 v7, 4, v6
  v_and_b32 v8, 1, v1
  v_lshlrev_b32 v8, 4, v8
  s_lshl_b32 s24, s48, 8
  v_add_u32 v8, s24, v8
  v_lshl_add_u32 v8, v4, 12, v8
  v_lshl_add_u32 v10, v6, 5, v8
  v_lshl_add_u32 v11, v7, 5, v8
  v_add_u32 v11, 0x4000, v11
  v_lshlrev_b32 v12, 4, v0
  s_mul_i32 s25, s49, 229376
  s_lshl_b32 s26, s3, 11
  s_add_u32 s26, s26, 3072
  s_lshl_b32 s27, s3, 10
  s_add_u32 s27, s27, 19456
  s_mov_b32 s28, 0x24924925
  v_mul_hi_u32 v13, v0, s28
  v_lshrrev_b32 v13, 4, v13
  v_mul_u32_u24 v14, 112, v13
  v_sub_u32 v14, v0, v14
  v_mul_u32_u24 v15, 7168, v13
  v_lshl_add_u32 v15, v14, 2, v15
  v_cmp_gt_u32 vcc, 448, v0
  s_nop 1
  v_cndmask_b32 v15, 0, v15, vcc
  v_and_b32 v20, 15, v1
  v_lshrrev_b32 v21, 4, v1
  s_and_b32 s29, s3, 3
  s_lshr_b32 s30, s3, 2
  v_lshrrev_b32 v22, 2, v20
  v_lshl_add_u32 v22, v21, 2, v22
  v_and_b32 v23, 7, v22
  s_lshl_b32 s31, s29, 1
  v_xor_b32 v24, s31, v23
  v_xor_b32 v25, 1, v24
  v_and_b32 v26, 3, v20
  v_lshlrev_b32 v26, 3, v26
  v_lshl_add_u32 v26, v22, 8, v26
  v_add_u32 v26, 3072, v26
  v_lshl_add_u32 v24, v24, 5, v26
  v_lshl_add_u32 v25, v25, 5, v26
  s_lshl_b32 s31, s30, 12
  s_add_u32 s31, s31, 19456
  v_lshl_add_u32 v27, v1, 4, s31
  v_mov_b32 v96, s22
  v_mov_b32 v97, s22
  v_mov_b32 v98, s22
  v_mov_b32 v99, s22
  s_lshl_b32 s31, s48, 17
  s_lshl_b32 s32, s29, 15
  s_add_u32 s31, s31, s32
  s_lshl_b32 s32, s49, 10
  s_add_u32 s31, s31, s32
  s_add_u32 s31, s31, 0x400000
  v_lshl_add_u32 v19, v1, 4, s31
  v_add_u32 v18, 0x4000, v19
  s_mul_i32 s28, s49, 448
  s_add_u32 s28, s28, 0x1320000
  s_barrier
  buffer_load_dword v16, v15, s[36:39], s28 offen
  s_cmp_ge_u32 s3, 4
  s_cbranch_scc1 K3_B
  s_mov_b32 s50, 0
  s_mov_b32 s51, 0
  s_mov_b32 s52, s25
  s_mov_b32 s54, 0
K3_PLA:
  s_add_u32 m0, s26, s50
  s_nop 0
  buffer_load_dwordx4 v10, s[8:11], s51 offen lds
  s_add_u32 m0, m0, 1024
  s_nop 0
  buffer_load_dwordx4 v11, s[8:11], s51 offen lds
  s_add_u32 s51, s51, 0x40000
  s_add_u32 m0, s27, s50
  s_nop 0
  buffer_load_dwordx4 v12, s[12:15], s52 offen lds
  s_add_u32 s52, s52, 8192
  s_add_u32 m0, m0, 8192
  s_nop 0
  buffer_load_dwordx4 v12, s[12:15], s52 offen lds
  s_add_u32 s52, s52, 8192
  s_add_u32 m0, m0, 8192
  s_nop 0
  buffer_load_dwordx4 v12, s[12:15], s52 offen lds
  s_add_u32 s52, s52, 8192
  s_add_u32 m0, m0, 8192
  s_nop 0
  buffer_load_dwordx4 v12, s[12:15], s52 offen lds
  s_add_u32 s52, s52, 4096
  s_add_u32 s50, s50, 45056
  s_cmp_lt_u32 s50, 90112
  s_cbranch_scc1 K3_PLA
  s_mov_b32 s53, 45056
  v_mov_b32 v3, v24
  v_mov_b32 v4, v25
  v_mov_b32 v5, v27
  s_waitcnt vmcnt(6)
  v_lshlrev_b32 v15, 2, v0
  ds_write_b32 v15, v16
  s_barrier
  ds_read_b64_tr_b16 v[32:33], v3 offset:0
  ds_read_b64_tr_b16 v[34:35], v3 offset:4096
  ds_read_b64_tr_b16 v[36:37], v4 offset:0
  ds_read_b64_tr_b16 v[38:39], v4 offset:4096
  ds_read_b128 v[48:51], v5 offset:0
  ds_read_b128 v[52:55], v5 offset:1024
  ds_read_b128 v[56:59], v5 offset:2048
  ds_read_b128 v[60:63], v5 offset:3072
  ds_read_b128 v[64:67], v5 offset:7168
  ds_read_b128 v[68:71], v5 offset:8192
  ds_read_b128 v[72:75], v5 offset:9216
  ds_read_b128 v[76:79], v5 offset:10240
  s_waitcnt lgkmcnt(0)
  v_mfma_f32_16x16x32_bf16 v[192:195], v[48:51], v[32:35], 0
  ds_read_b64_tr_b16 v[40:41], v3 offset:8192
  v_mfma_f32_16x16x32_bf16 v[196:199], v[48:51], v[36:39], 0
  ds_read_b64_tr_b16 v[42:43], v3 offset:12288
  s_add_u32 m0, s26, s50
  s_nop 0
  buffer_load_dwordx4 v10, s[8:11], s51 offen lds
  v_mfma_f32_16x16x32_bf16 v[200:203], v[52:55], v[32:35], 0
  ds_read_b64_tr_b16 v[44:45], v4 offset:8192
  v_mfma_f32_16x16x32_bf16 v[204:207], v[52:55], v[36:39], 0
  ds_read_b64_tr_b16 v[46:47], v4 offset:12288
  s_add_u32 m0, m0, 1024
  s_nop 0
  buffer_load_dwordx4 v11, s[8:11], s51 offen lds
  s_add_u32 s51, s51, 0x40000
  v_mfma_f32_16x16x32_bf16 v[208:211], v[56:59], v[32:35], 0
  ds_read_b128 v[80:83], v5 offset:14336
  v_mfma_f32_16x16x32_bf16 v[212:215], v[56:59], v[36:39], 0
  ds_read_b128 v[84:87], v5 offset:15360
  s_add_u32 m0, s27, s50
  s_nop 0
  buffer_load_dwordx4 v12, s[12:15], s52 offen lds
  s_add_u32 s52, s52, 8192
  v_mfma_f32_16x16x32_bf16 v[216:219], v[60:63], v[32:35], 0
  ds_read_b128 v[88:91], v5 offset:16384
  v_mfma_f32_16x16x32_bf16 v[220:223], v[60:63], v[36:39], 0
  ds_read_b128 v[92:95], v5 offset:17408
  s_add_u32 m0, m0, 8192
  s_nop 0
  buffer_load_dwordx4 v12, s[12:15], s52 offen lds
  s_add_u32 s52, s52, 8192
  v_mfma_f32_16x16x32_bf16 v[224:227], v[64:67], v[32:35], 0
  ds_read_b128 v[96:99], v5 offset:21504
  v_mfma_f32_16x16x32_bf16 v[228:231], v[64:67], v[36:39], 0
  ds_read_b128 v[100:103], v5 offset:22528
  s_add_u32 m0, m0, 8192
  s_nop 0
  buffer_load_dwordx4 v12, s[12:15], s52 offen lds
  s_add_u32 s52, s52, 8192
  v_mfma_f32_16x16x32_bf16 v[232:235], v[68:71], v[32:35], 0
  ds_read_b128 v[104:107], v5 offset:23552
  v_mfma_f32_16x16x32_bf16 v[236:239], v[68:71], v[36:39], 0
  ds_read_b128 v[108:111], v5 offset:24576
  s_add_u32 m0, m0, 8192
  s_nop 0
  buffer_load_dwordx4 v12, s[12:15], s52 offen lds
  s_add_u32 s52, s52, 4096
  v_mfma_f32_16x16x32_bf16 v[240:243], v[72:75], v[32:35], 0
  v_mfma_f32_16x16x32_bf16 v[244:247], v[72:75], v[36:39], 0
  v_mfma_f32_16x16x32_bf16 v[248:251], v[76:79], v[32:35], 0
  v_mfma_f32_16x16x32_bf16 v[252:255], v[76:79], v[36:39], 0
  s_cmp_lg_u32 s49, s54
  s_cbranch_scc1 K3_NX0
  buffer_store_dwordx4 v[32:35], v19, s[36:39], 0 offen sc1
  buffer_store_dwordx4 v[36:39], v18, s[36:39], 0 offen sc1
  s_nop 1
K3_NX0:
  s_add_u32 s54, s54, 1
  s_mov_b32 s50, 0
K3_LA:
  v_add_u32 v3, s53, v24
  v_add_u32 v4, s53, v25
  v_add_u32 v5, s53, v27
  s_waitcnt lgkmcnt(0)
  s_waitcnt vmcnt(6)
  s_barrier
  v_mfma_f32_16x16x32_bf16 v[192:195], v[80:83], v[40:43], v[192:195]
  ds_read_b64_tr_b16 v[32:33], v3 offset:0
  v_mfma_f32_16x16x32_bf16 v[196:199], v[80:83], v[44:47], v[196:199]
  ds_read_b64_tr_b16 v[34:35], v3 offset:4096
  v_mfma_f32_16x16x32_bf16 v[200:203], v[84:87], v[40:43], v[200:203]
  ds_read_b64_tr_b16 v[36:37], v4 offset:0
  v_mfma_f32_16x16x32_bf16 v[204:207], v[84:87], v[44:47], v[204:207]
  ds_read_b64_tr_b16 v[38:39], v4 offset:4096
  s_add_u32 m0, s26, s50
  s_nop 0
  buffer_load_dwordx4 v10, s[8:11], s51 offen lds
  v_mfma_f32_16x16x32_bf16 v[208:211], v[88:91], v[40:43], v[208:211]
  ds_read_b128 v[48:51], v5 offset:0
  v_mfma_f32_16x16x32_bf16 v[212:215], v[88:91], v[44:47], v[212:215]
  ds_read_b128 v[52:55], v5 offset:1024
  v_mfma_f32_16x16x32_bf16 v[216:219], v[92:95], v[40:43], v[216:219]
  ds_read_b128 v[56:59], v5 offset:2048
  v_mfma_f32_16x16x32_bf16 v[220:223], v[92:95], v[44:47], v[220:223]
  ds_read_b128 v[60:63], v5 offset:3072
  s_add_u32 m0, m0, 1024
  s_nop 0
  buffer_load_dwordx4 v11, s[8:11], s51 offen lds
  s_add_u32 s51, s51, 0x40000
  v_mfma_f32_16x16x32_bf16 v[224:227], v[96:99], v[40:43], v[224:227]
  ds_read_b128 v[64:67], v5 offset:7168
  v_mfma_f32_16x16x32_bf16 v[228:231], v[96:99], v[44:47], v[228:231]
  ds_read_b128 v[68:71], v5 offset:8192
  v_mfma_f32_16x16x32_bf16 v[232:235], v[100:103], v[40:43], v[232:235]
  ds_read_b128 v[72:75], v5 offset:9216
  v_mfma_f32_16x16x32_bf16 v[236:239], v[100:103], v[44:47], v[236:239]
  ds_read_b128 v[76:79], v5 offset:10240
  s_add_u32 m0, s27, s50
  s_nop 0
  buffer_load_dwordx4 v12, s[12:15], s52 offen lds
  s_add_u32 s52, s52, 8192
  v_mfma_f32_16x16x32_bf16 v[240:243], v[104:107], v[40:43], v[240:243]
  v_mfma_f32_16x16x32_bf16 v[244:247], v[104:107], v[44:47], v[244:247]
  v_mfma_f32_16x16x32_bf16 v[248:251], v[108:111], v[40:43], v[248:251]
  v_mfma_f32_16x16x32_bf16 v[252:255], v[108:111], v[44:47], v[252:255]
  s_cmp_lg_u32 s49, s54
  s_cbranch_scc1 K3_NX1
  buffer_store_dwordx4 v[40:43], v19, s[36:39], 0 offen sc1
  buffer_store_dwordx4 v[44:47], v18, s[36:39], 0 offen sc1
  s_nop 1
K3_NX1:
  s_add_u32 s54, s54, 1
  s_waitcnt lgkmcnt(0)
  v_mfma_f32_16x16x32_bf16 v[192:195], v[48:51], v[32:35], v[192:195]
  ds_read_b64_tr_b16 v[40:41], v3 offset:8192
  v_mfma_f32_16x16x32_bf16 v[196:199], v[48:51], v[36:39], v[196:199]
  ds_read_b64_tr_b16 v[42:43], v3 offset:12288
  v_mfma_f32_16x16x32_bf16 v[200:203], v[52:55], v[32:35], v[200:203]
  ds_read_b64_tr_b16 v[44:45], v4 offset:8192
  v_mfma_f32_16x16x32_bf16 v[204:207], v[52:55], v[36:39], v[204:207]
  ds_read_b64_tr_b16 v[46:47], v4 offset:12288
  s_add_u32 m0, m0, 8192
  s_nop 0
  buffer_load_dwordx4 v12, s[12:15], s52 offen lds
  s_add_u32 s52, s52, 8192
  v_mfma_f32_16x16x32_bf16 v[208:211], v[56:59], v[32:35], v[208:211]
  ds_read_b128 v[80:83], v5 offset:14336
  v_mfma_f32_16x16x32_bf16 v[212:215], v[56:59], v[36:39], v[212:215]
  ds_read_b128 v[84:87], v5 offset:15360
  v_mfma_f32_16x16x32_bf16 v[216:219], v[60:63], v[32:35], v[216:219]
  ds_read_b128 v[88:91], v5 offset:16384
  v_mfma_f32_16x16x32_bf16 v[220:223], v[60:63], v[36:39], v[220:223]
  ds_read_b128 v[92:95], v5 offset:17408
  s_add_u32 m0, m0, 8192
  s_nop 0
  buffer_load_dwordx4 v12, s[12:15], s52 offen lds
  s_add_u32 s52, s52, 8192
  v_mfma_f32_16x16x32_bf16 v[224:227], v[64:67], v[32:35], v[224:227]
  ds_read_b128 v[96:99], v5 offset:21504
  v_mfma_f32_16x16x32_bf16 v[228:231], v[64:67], v[36:39], v[228:231]
  ds_read_b128 v[100:103], v5 offset:22528
  v_mfma_f32_16x16x32_bf16 v[232:235], v[68:71], v[32:35], v[232:235]
  ds_read_b128 v[104:107], v5 offset:23552
  v_mfma_f32_16x16x32_bf16 v[236:239], v[68:71], v[36:39], v[236:239]
  ds_read_b128 v[108:111], v5 offset:24576
  s_add_u32 m0, m0, 8192
  s_nop 0
  buffer_load_dwordx4 v12, s[12:15], s52 offen lds
  s_add_u32 s52, s52, 4096
  v_mfma_f32_16x16x32_bf16 v[240:243], v[72:75], v[32:35], v[240:243]
  v_mfma_f32_16x16x32_bf16 v[244:247], v[72:75], v[36:39], v[244:247]
  v_mfma_f32_16x16x32_bf16 v[248:251], v[76:79], v[32:35], v[248:251]
  v_mfma_f32_16x16x32_bf16 v[252:255], v[76:79], v[36:39], v[252:255]
  s_cmp_lg_u32 s49, s54
  s_cbranch_scc1 K3_NX2
  buffer_store_dwordx4 v[32:35], v19, s[36:39], 0 offen sc1
  buffer_store_dwordx4 v[36:39], v18, s[36:39], 0 offen sc1
  s_nop 1
K3_NX2:
  s_add_u32 s54, s54, 1
  s_mov_b32 s50, s53
  s_add_u32 s53, s53, 45056
  s_cmp_eq_u32 s53, 135168
  s_cselect_b32 s53, 0, s53
  s_cmp_lt_u32 s54, 15
  s_cbranch_scc1 K3_LA
  s_waitcnt lgkmcnt(0)
  v_mfma_f32_16x16x32_bf16 v[192:195], v[80:83], v[40:43], v[192:195]
  v_mfma_f32_16x16x32_bf16 v[196:199], v[80:83], v[44:47], v[196:199]
  v_mfma_f32_16x16x32_bf16 v[200:203], v[84:87], v[40:43], v[200:203]
  v_mfma_f32_16x16x32_bf16 v[204:207], v[84:87], v[44:47], v[204:207]
  v_mfma_f32_16x16x32_bf16 v[208:211], v[88:91], v[40:43], v[208:211]
  v_mfma_f32_16x16x32_bf16 v[212:215], v[88:91], v[44:47], v[212:215]
  v_mfma_f32_16x16x32_bf16 v[216:219], v[92:95], v[40:43], v[216:219]
  v_mfma_f32_16x16x32_bf16 v[220:223], v[92:95], v[44:47], v[220:223]
  v_mfma_f32_16x16x32_bf16 v[224:227], v[96:99], v[40:43], v[224:227]
  v_mfma_f32_16x16x32_bf16 v[228:231], v[96:99], v[44:47], v[228:231]
  v_mfma_f32_16x16x32_bf16 v[232:235], v[100:103], v[40:43], v[232:235]
  v_mfma_f32_16x16x32_bf16 v[236:239], v[100:103], v[44:47], v[236:239]
  v_mfma_f32_16x16x32_bf16 v[240:243], v[104:107], v[40:43], v[240:243]
  v_mfma_f32_16x16x32_bf16 v[244:247], v[104:107], v[44:47], v[244:247]
  v_mfma_f32_16x16x32_bf16 v[248:251], v[108:111], v[40:43], v[248:251]
  v_mfma_f32_16x16x32_bf16 v[252:255], v[108:111], v[44:47], v[252:255]
  s_cmp_lg_u32 s49, s54
  s_cbranch_scc1 K3_NX3
  buffer_store_dwordx4 v[40:43], v19, s[36:39], 0 offen sc1
  buffer_store_dwordx4 v[44:47], v18, s[36:39], 0 offen sc1
  s_nop 1
K3_NX3:
  s_add_u32 s54, s54, 1
  s_mov_b32 s55, 0
  s_mov_b32 s56, 4
  s_mov_b32 s58, 32
  s_waitcnt vmcnt(0)
  s_barrier
  s_branch K3_EP
K3_B:
  s_mov_b32 s50, 0
  s_mov_b32 s51, 0
  s_mov_b32 s52, s25
  s_mov_b32 s54, 0
K3_PLB:
  s_add_u32 m0, s26, s50
  s_nop 0
  buffer_load_dwordx4 v10, s[8:11], s51 offen lds
  s_add_u32 m0, m0, 1024
  s_nop 0
  buffer_load_dwordx4 v11, s[8:11], s51 offen lds
  s_add_u32 s51, s51, 0x40000
  s_add_u32 m0, s27, s50
  s_nop 0
  buffer_load_dwordx4 v12, s[12:15], s52 offen lds
  s_add_u32 s52, s52, 8192
  s_add_u32 m0, m0, 8192
  s_nop 0
  buffer_load_dwordx4 v12, s[12:15], s52 offen lds
  s_add_u32 s52, s52, 8192
  s_add_u32 m0, m0, 8192
  s_nop 0
  buffer_load_dwordx4 v12, s[12:15], s52 offen lds
  s_add_u32 s52, s52, 12288
  s_add_u32 s50, s50, 45056
  s_cmp_lt_u32 s50, 90112
  s_cbranch_scc1 K3_PLB
  s_mov_b32 s53, 45056
  v_mov_b32 v3, v24
  v_mov_b32 v4, v25
  v_mov_b32 v5, v27
  s_waitcnt vmcnt(5)
  v_lshlrev_b32 v15, 2, v0
  ds_write_b32 v15, v16
  s_barrier
  ds_read_b64_tr_b16 v[32:33], v3 offset:0
  ds_read_b64_tr_b16 v[34:35], v3 offset:4096
  ds_read_b64_tr_b16 v[36:37], v4 offset:0
  ds_read_b64_tr_b16 v[38:39], v4 offset:4096
  ds_read_b128 v[48:51], v5 offset:0
  ds_read_b128 v[52:55], v5 offset:1024
  ds_read_b128 v[56:59], v5 offset:2048
  ds_read_b128 v[60:63], v5 offset:7168
  ds_read_b128 v[64:67], v5 offset:8192
  ds_read_b128 v[68:71], v5 offset:9216
  s_waitcnt lgkmcnt(0)
  v_mfma_f32_16x16x32_bf16 v[192:195], v[48:51], v[32:35], 0
  ds_read_b64_tr_b16 v[40:41], v3 offset:8192
  v_mfma_f32_16x16x32_bf16 v[196:199], v[48:51], v[36:39], 0
  ds_read_b64_tr_b16 v[42:43], v3 offset:12288
  v_mfma_f32_16x16x32_bf16 v[240:243], v[96:99], v[32:35], 0
  s_add_u32 m0, s26, s50
  s_nop 0
  buffer_load_dwordx4 v10, s[8:11], s51 offen lds
  v_mfma_f32_16x16x32_bf16 v[200:203], v[52:55], v[32:35], 0
  ds_read_b64_tr_b16 v[44:45], v4 offset:8192
  v_mfma_f32_16x16x32_bf16 v[204:207], v[52:55], v[36:39], 0
  ds_read_b64_tr_b16 v[46:47], v4 offset:12288
  s_add_u32 m0, m0, 1024
  s_nop 0
  buffer_load_dwordx4 v11, s[8:11], s51 offen lds
  s_add_u32 s51, s51, 0x40000
  v_mfma_f32_16x16x32_bf16 v[208:211], v[56:59], v[32:35], 0
  ds_read_b128 v[72:75], v5 offset:14336
  v_mfma_f32_16x16x32_bf16 v[244:247], v[96:99], v[36:39], 0
  v_mfma_f32_16x16x32_bf16 v[212:215], v[56:59], v[36:39], 0
  ds_read_b128 v[76:79], v5 offset:15360
  s_add_u32 m0, s27, s50
  s_nop 0
  buffer_load_dwordx4 v12, s[12:15], s52 offen lds
  s_add_u32 s52, s52, 8192
  v_mfma_f32_16x16x32_bf16 v[216:219], v[60:63], v[32:35], 0
  ds_read_b128 v[80:83], v5 offset:16384
  v_mfma_f32_16x16x32_bf16 v[220:223], v[60:63], v[36:39], 0
  ds_read_b128 v[84:87], v5 offset:21504
  v_mfma_f32_16x16x32_bf16 v[248:251], v[32:35], v[32:35], 0
  s_add_u32 m0, m0, 8192
  s_nop 0
  buffer_load_dwordx4 v12, s[12:15], s52 offen lds
  s_add_u32 s52, s52, 8192
  v_mfma_f32_16x16x32_bf16 v[224:227], v[64:67], v[32:35], 0
  ds_read_b128 v[88:91], v5 offset:22528
  v_mfma_f32_16x16x32_bf16 v[228:231], v[64:67], v[36:39], 0
  ds_read_b128 v[92:95], v5 offset:23552
  s_add_u32 m0, m0, 8192
  s_nop 0
  buffer_load_dwordx4 v12, s[12:15], s52 offen lds
  s_add_u32 s52, s52, 12288
  v_mfma_f32_16x16x32_bf16 v[232:235], v[68:71], v[32:35], 0
  v_mfma_f32_16x16x32_bf16 v[252:255], v[36:39], v[36:39], 0
  v_mfma_f32_16x16x32_bf16 v[236:239], v[68:71], v[36:39], 0
  s_add_u32 s54, s54, 1
  s_mov_b32 s50, 0
K3_LB:
  v_add_u32 v3, s53, v24
  v_add_u32 v4, s53, v25
  v_add_u32 v5, s53, v27
  s_waitcnt lgkmcnt(0)
  s_waitcnt vmcnt(5)
  s_barrier
  v_mfma_f32_16x16x32_bf16 v[192:195], v[72:75], v[40:43], v[192:195]
  ds_read_b64_tr_b16 v[32:33], v3 offset:0
  v_mfma_f32_16x16x32_bf16 v[196:199], v[72:75], v[44:47], v[196:199]
  ds_read_b64_tr_b16 v[34:35], v3 offset:4096
  v_mfma_f32_16x16x32_bf16 v[240:243], v[96:99], v[40:43], v[240:243]
  v_mfma_f32_16x16x32_bf16 v[200:203], v[76:79], v[40:43], v[200:203]
  ds_read_b64_tr_b16 v[36:37], v4 offset:0
  v_mfma_f32_16x16x32_bf16 v[204:207], v[76:79], v[44:47], v[204:207]
  ds_read_b64_tr_b16 v[38:39], v4 offset:4096
  s_add_u32 m0, s26, s50
  s_nop 0
  buffer_load_dwordx4 v10, s[8:11], s51 offen lds
  v_mfma_f32_16x16x32_bf16 v[208:211], v[80:83], v[40:43], v[208:211]
  ds_read_b128 v[48:51], v5 offset:0
  v_mfma_f32_16x16x32_bf16 v[244:247], v[96:99], v[44:47], v[244:247]
  v_mfma_f32_16x16x32_bf16 v[212:215], v[80:83], v[44:47], v[212:215]
  ds_read_b128 v[52:55], v5 offset:1024
  v_mfma_f32_16x16x32_bf16 v[216:219], v[84:87], v[40:43], v[216:219]
  ds_read_b128 v[56:59], v5 offset:2048
  v_mfma_f32_16x16x32_bf16 v[220:223], v[84:87], v[44:47], v[220:223]
  ds_read_b128 v[60:63], v5 offset:7168
  v_mfma_f32_16x16x32_bf16 v[248:251], v[40:43], v[40:43], v[248:251]
  s_add_u32 m0, m0, 1024
  s_nop 0
  buffer_load_dwordx4 v11, s[8:11], s51 offen lds
  s_add_u32 s51, s51, 0x40000
  v_mfma_f32_16x16x32_bf16 v[224:227], v[88:91], v[40:43], v[224:227]
  ds_read_b128 v[64:67], v5 offset:8192
  v_mfma_f32_16x16x32_bf16 v[228:231], v[88:91], v[44:47], v[228:231]
  ds_read_b128 v[68:71], v5 offset:9216
  v_mfma_f32_16x16x32_bf16 v[232:235], v[92:95], v[40:43], v[232:235]
  v_mfma_f32_16x16x32_bf16 v[252:255], v[44:47], v[44:47], v[252:255]
  v_mfma_f32_16x16x32_bf16 v[236:239], v[92:95], v[44:47], v[236:239]
  s_add_u32 m0, s27, s50
  s_nop 0
  buffer_load_dwordx4 v12, s[12:15], s52 offen lds
  s_add_u32 s52, s52, 8192
  s_add_u32 s54, s54, 1
  s_waitcnt lgkmcnt(0)
  v_mfma_f32_16x16x32_bf16 v[192:195], v[48:51], v[32:35], v[192:195]
  ds_read_b64_tr_b16 v[40:41], v3 offset:8192
  v_mfma_f32_16x16x32_bf16 v[196:199], v[48:51], v[36:39], v[196:199]
  ds_read_b64_tr_b16 v[42:43], v3 offset:12288
  v_mfma_f32_16x16x32_bf16 v[240:243], v[96:99], v[32:35], v[240:243]
  v_mfma_f32_16x16x32_bf16 v[200:203], v[52:55], v[32:35], v[200:203]
  ds_read_b64_tr_b16 v[44:45], v4 offset:8192
  v_mfma_f32_16x16x32_bf16 v[204:207], v[52:55], v[36:39], v[204:207]
  ds_read_b64_tr_b16 v[46:47], v4 offset:12288
  s_add_u32 m0, m0, 8192
  s_nop 0
  buffer_load_dwordx4 v12, s[12:15], s52 offen lds
  s_add_u32 s52, s52, 8192
  v_mfma_f32_16x16x32_bf16 v[208:211], v[56:59], v[32:35], v[208:211]
  ds_read_b128 v[72:75], v5 offset:14336
  v_mfma_f32_16x16x32_bf16 v[244:247], v[96:99], v[36:39], v[244:247]
  v_mfma_f32_16x16x32_bf16 v[212:215], v[56:59], v[36:39], v[212:215]
  ds_read_b128 v[76:79], v5 offset:15360
  v_mfma_f32_16x16x32_bf16 v[216:219], v[60:63], v[32:35], v[216:219]
  ds_read_b128 v[80:83], v5 offset:16384
  v_mfma_f32_16x16x32_bf16 v[220:223], v[60:63], v[36:39], v[220:223]
  ds_read_b128 v[84:87], v5 offset:21504
  v_mfma_f32_16x16x32_bf16 v[248:251], v[32:35], v[32:35], v[248:251]
  s_add_u32 m0, m0, 8192
  s_nop 0
  buffer_load_dwordx4 v12, s[12:15], s52 offen lds
  s_add_u32 s52, s52, 12288
  v_mfma_f32_16x16x32_bf16 v[224:227], v[64:67], v[32:35], v[224:227]
  ds_read_b128 v[88:91], v5 offset:22528
  v_mfma_f32_16x16x32_bf16 v[228:231], v[64:67], v[36:39], v[228:231]
  ds_read_b128 v[92:95], v5 offset:23552
  v_mfma_f32_16x16x32_bf16 v[232:235], v[68:71], v[32:35], v[232:235]
  v_mfma_f32_16x16x32_bf16 v[252:255], v[36:39], v[36:39], v[252:255]
  v_mfma_f32_16x16x32_bf16 v[236:239], v[68:71], v[36:39], v[236:239]
  s_add_u32 s54, s54, 1
  s_mov_b32 s50, s53
  s_add_u32 s53, s53, 45056
  s_cmp_eq_u32 s53, 135168
  s_cselect_b32 s53, 0, s53
  s_cmp_lt_u32 s54, 15
  s_cbranch_scc1 K3_LB
  s_waitcnt lgkmcnt(0)
  v_mfma_f32_16x16x32_bf16 v[192:195], v[72:75], v[40:43], v[192:195]
  v_mfma_f32_16x16x32_bf16 v[196:199], v[72:75], v[44:47], v[196:199]
  v_mfma_f32_16x16x32_bf16 v[240:243], v[96:99], v[40:43], v[240:243]
  v_mfma_f32_16x16x32_bf16 v[200:203], v[76:79], v[40:43], v[200:203]
  v_mfma_f32_16x16x32_bf16 v[204:207], v[76:79], v[44:47], v[204:207]
  v_mfma_f32_16x16x32_bf16 v[208:211], v[80:83], v[40:43], v[208:211]
  v_mfma_f32_16x16x32_bf16 v[244:247], v[96:99], v[44:47], v[244:247]
  v_mfma_f32_16x16x32_bf16 v[212:215], v[80:83], v[44:47], v[212:215]
  v_mfma_f32_16x16x32_bf16 v[216:219], v[84:87], v[40:43], v[216:219]
  v_mfma_f32_16x16x32_bf16 v[220:223], v[84:87], v[44:47], v[220:223]
  v_mfma_f32_16x16x32_bf16 v[248:251], v[40:43], v[40:43], v[248:251]
  v_mfma_f32_16x16x32_bf16 v[224:227], v[88:91], v[40:43], v[224:227]
  v_mfma_f32_16x16x32_bf16 v[228:231], v[88:91], v[44:47], v[228:231]
  v_mfma_f32_16x16x32_bf16 v[232:235], v[92:95], v[40:43], v[232:235]
  v_mfma_f32_16x16x32_bf16 v[252:255], v[44:47], v[44:47], v[252:255]
  v_mfma_f32_16x16x32_bf16 v[236:239], v[92:95], v[44:47], v[236:239]
  s_add_u32 s54, s54, 1
  v_and_b32 v36, 3, v20
  v_lshrrev_b32 v37, 2, v20
  s_nop 4
  v_mov_b32 v30, v248
  v_cmp_eq_u32 vcc, 1, v36
  s_nop 1
  v_cndmask_b32 v30, v30, v249, vcc
  v_cmp_eq_u32 vcc, 2, v36
  s_nop 1
  v_cndmask_b32 v30, v30, v250, vcc
  v_cmp_eq_u32 vcc, 3, v36
  s_nop 1
  v_cndmask_b32 v30, v30, v251, vcc
  v_mov_b32 v31, v252
  v_cmp_eq_u32 vcc, 1, v36
  s_nop 1
  v_cndmask_b32 v31, v31, v253, vcc
  v_cmp_eq_u32 vcc, 2, v36
  s_nop 1
  v_cndmask_b32 v31, v31, v254, vcc
  v_cmp_eq_u32 vcc, 3, v36
  s_nop 1
  v_cndmask_b32 v31, v31, v255, vcc
  v_mul_f32 v32, 0x3b000000, v240
  v_mul_f32 v40, 0x3b000000, v30
  v_fma_f32 v40, -v32, v32, v40
  v_max_f32 v40, 0, v40
  v_cvt_pk_bf16_f32 v40, v40, v40
  v_lshlrev_b32 v40, 16, v40
  v_add_f32 v40, 0x3727c5ac, v40
  v_cvt_pk_bf16_f32 v40, v40, v40
  v_lshlrev_b32 v40, 16, v40
  v_sqrt_f32 v40, v40
  s_nop 0
  v_cvt_pk_bf16_f32 v40, v40, v40
  v_lshlrev_b32 v40, 16, v40
  v_rcp_f32 v33, v40
  v_cvt_pk_bf16_f32 v32, v32, v32
  v_lshlrev_b32 v32, 16, v32
  v_mul_f32 v34, 0x3b000000, v244
  v_mul_f32 v41, 0x3b000000, v31
  v_fma_f32 v41, -v34, v34, v41
  v_max_f32 v41, 0, v41
  v_cvt_pk_bf16_f32 v41, v41, v41
  v_lshlrev_b32 v41, 16, v41
  v_add_f32 v41, 0x3727c5ac, v41
  v_cvt_pk_bf16_f32 v41, v41, v41
  v_lshlrev_b32 v41, 16, v41
  v_sqrt_f32 v41, v41
  s_nop 0
  v_cvt_pk_bf16_f32 v41, v41, v41
  v_lshlrev_b32 v41, 16, v41
  v_rcp_f32 v35, v41
  v_cvt_pk_bf16_f32 v34, v34, v34
  v_lshlrev_b32 v34, 16, v34
  s_lshl_b32 s31, s29, 8
  s_add_u32 s31, s31, 2048
  v_lshl_add_u32 v22, v20, 3, s31
  v_cmp_eq_u32 vcc, v37, v21
  s_and_saveexec_b64 s[44:45], vcc
  ds_write_b64 v22, v[32:33]
  ds_write_b64 v22, v[34:35] offset:128
  s_mov_b64 exec, s[44:45]
  s_waitcnt vmcnt(0) lgkmcnt(0)
  s_barrier
  s_mov_b32 s55, 4
  s_mov_b32 s56, 7
  s_mov_b32 s58, 24
K3_EP:
  s_nop 7
  s_and_b32 s31, s2, 7
  s_lshl_b32 s50, s31, 2
  s_lshr_b32 s33, s2, 6
  s_add_u32 s50, s50, s33
  s_bfe_u32 s51, s2, 0x30003
  s_add_u32 s8, s4, 0xc00000
  s_addc_u32 s9, s5, 0
  s_mov_b32 s10, 0x700000
  s_mov_b32 s11, 0x00020000
  s_add_u32 s12, s4, 0xa00000
  s_addc_u32 s13, s5, 0
  s_mov_b32 s14, 0x1c0000
  s_mov_b32 s15, 0x00020000
  s_mul_i32 s52, s50, 229376
  s_mul_i32 s53, s51, 229376
  s_lshl_b32 s33, s3, 12
  s_add_u32 s52, s52, s33
  s_add_u32 s53, s53, s33
  v_lshlrev_b32 v3, 4, v1
  s_lshl_b32 s54, s3, 14
  s_add_u32 s54, s54, 3072
  s_mov_b32 s30, s54
  s_cmp_lt_u32 s3, 4
  s_cbranch_scc1 K3_EG
  s_mov_b32 m0, s30
  s_nop 0
  buffer_load_dwordx4 v3, s[12:15], s53 offen offset:0 lds
  buffer_load_dwordx4 v3, s[12:15], s53 offen offset:1024 lds
  buffer_load_dwordx4 v3, s[12:15], s53 offen offset:2048 lds
  buffer_load_dwordx4 v3, s[12:15], s53 offen offset:3072 lds
  s_add_u32 s53, s53, 32768
  s_add_u32 s30, s30, 4096
K3_EG:
  s_lshl_b32 s31, s29, 8
  s_add_u32 s31, s31, 2048
  v_lshl_add_u32 v22, v20, 3, s31
  ds_read_b64 v[32:33], v22
  ds_read_b64 v[34:35], v22 offset:128
  s_lshl_b32 s31, s55, 6
  v_lshl_add_u32 v23, v21, 4, s31
  s_lshl_b32 s31, s48, 1
  s_lshr_b32 s32, s29, 1
  s_add_u32 s31, s31, s32
  s_mul_i32 s31, s31, 229376
  s_add_u32 s31, s31, 0xc00000
  v_lshl_add_u32 v26, v1, 4, s31
  s_and_b32 s32, s29, 1
  s_lshl_b32 s32, s32, 11
  s_mul_i32 s33, s49, 12288
  s_add_u32 s33, s33, s32
  s_lshl_b32 s31, s55, 11
  s_add_u32 s33, s33, s31
  s_lshr_b32 s31, s49, 1
  s_add_u32 s31, s31, 48
  s_lshl_b32 s31, s31, 12
  s_add_u32 s31, s31, s32
  s_and_b32 s32, s49, 1
  s_lshl_b32 s32, s32, 10
  s_add_u32 s34, s31, s32
  s_mov_b32 s57, 0
K3_EL:
  ds_read_b128 v[72:75], v23 offset:0
  ds_read_b128 v[76:79], v23 offset:448
  ds_read_b128 v[80:83], v23 offset:896
  ds_read_b128 v[84:87], v23 offset:1344
  v_add_u32 v23, 64, v23
  s_add_u32 s59, s57, s58
  s_mov_b32 m0, s30
  s_nop 0
  buffer_load_dwordx4 v3, s[12:15], s53 offen offset:0 lds
  buffer_load_dwordx4 v3, s[12:15], s53 offen offset:1024 lds
  buffer_load_dwordx4 v3, s[12:15], s53 offen offset:2048 lds
  buffer_load_dwordx4 v3, s[12:15], s53 offen offset:3072 lds
  s_add_u32 s53, s53, 32768
  s_add_u32 s30, s30, 4096
  v_mov_b32 v36, v38
  v_mov_b32 v37, v39
  v_mov_b32 v40, v42
  v_mov_b32 v41, v43
  s_waitcnt lgkmcnt(0)
  s_set_gpr_idx_on s57, gpr_idx(SRC2)
  s_nop 0
  v_fma_f32 v88, -v32, v72, v192
  v_fma_f32 v89, -v32, v73, v193
  v_fma_f32 v90, -v32, v74, v194
  v_fma_f32 v91, -v32, v75, v195
  v_fma_f32 v92, -v34, v72, v196
  v_fma_f32 v93, -v34, v73, v197
  v_fma_f32 v94, -v34, v74, v198
  v_fma_f32 v95, -v34, v75, v199
  s_set_gpr_idx_off
  s_set_gpr_idx_on s59, gpr_idx(SRC2)
  s_nop 0
  v_fma_f32 v96, -v32, v80, v192
  v_fma_f32 v97, -v32, v81, v193
  v_fma_f32 v98, -v32, v82, v194
  v_fma_f32 v99, -v32, v83, v195
  v_fma_f32 v100, -v34, v80, v196
  v_fma_f32 v101, -v34, v81, v197
  v_fma_f32 v102, -v34, v82, v198
  v_fma_f32 v103, -v34, v83, v199
  s_set_gpr_idx_off
  v_fma_f32 v88, v33, v88, v76
  v_fma_f32 v89, v33, v89, v77
  v_fma_f32 v90, v33, v90, v78
  v_fma_f32 v91, v33, v91, v79
  v_fma_f32 v92, v35, v92, v76
  v_fma_f32 v93, v35, v93, v77
  v_fma_f32 v94, v35, v94, v78
  v_fma_f32 v95, v35, v95, v79
  v_mul_f32 v60, 0xbfb8aa3b, v88
  v_mul_f32 v61, 0xbfb8aa3b, v89
  v_mul_f32 v62, 0xbfb8aa3b, v90
  v_mul_f32 v63, 0xbfb8aa3b, v91
  v_mul_f32 v64, 0xbfb8aa3b, v92
  v_mul_f32 v65, 0xbfb8aa3b, v93
  v_mul_f32 v66, 0xbfb8aa3b, v94
  v_mul_f32 v67, 0xbfb8aa3b, v95
  v_exp_f32 v60, v60
  v_fma_f32 v96, v33, v96, v84
  v_exp_f32 v61, v61
  v_fma_f32 v97, v33, v97, v85
  v_exp_f32 v62, v62
  v_fma_f32 v98, v33, v98, v86
  v_exp_f32 v63, v63
  v_fma_f32 v99, v33, v99, v87
  v_exp_f32 v64, v64
  v_fma_f32 v100, v35, v100, v84
  v_exp_f32 v65, v65
  v_fma_f32 v101, v35, v101, v85
  v_exp_f32 v66, v66
  v_fma_f32 v102, v35, v102, v86
  v_exp_f32 v67, v67
  v_fma_f32 v103, v35, v103, v87
  v_add_f32 v60, 1.0, v60
  v_add_f32 v61, 1.0, v61
  v_add_f32 v62, 1.0, v62
  v_add_f32 v63, 1.0, v63
  v_add_f32 v64, 1.0, v64
  v_add_f32 v65, 1.0, v65
  v_add_f32 v66, 1.0, v66
  v_add_f32 v67, 1.0, v67
  v_rcp_f32 v60, v60
  v_mul_f32 v88, v88, v96
  v_rcp_f32 v61, v61
  v_mul_f32 v89, v89, v97
  v_rcp_f32 v62, v62
  v_mul_f32 v90, v90, v98
  v_rcp_f32 v63, v63
  v_mul_f32 v91, v91, v99
  v_rcp_f32 v64, v64
  v_mul_f32 v92, v92, v100
  v_rcp_f32 v65, v65
  v_mul_f32 v93, v93, v101
  v_rcp_f32 v66, v66
  v_mul_f32 v94, v94, v102
  v_rcp_f32 v67, v67
  v_mul_f32 v95, v95, v103
  v_mul_f32 v88, v88, v60
  v_mul_f32 v89, v89, v61
  v_mul_f32 v90, v90, v62
  v_mul_f32 v91, v91, v63
  v_mul_f32 v92, v92, v64
  v_mul_f32 v93, v93, v65
  v_mul_f32 v94, v94, v66
  v_mul_f32 v95, v95, v67
  v_cvt_pk_bf16_f32 v38, v88, v89
  v_cvt_pk_bf16_f32 v39, v90, v91
  v_cvt_pk_bf16_f32 v42, v92, v93
  v_cvt_pk_bf16_f32 v43, v94, v95
  s_bitcmp1_b32 s55, 0
  s_cbranch_scc0 K3_EN
  buffer_store_dwordx4 v[36:39], v26, s[36:39], s33 offen sc1
  buffer_store_dwordx4 v[40:43], v26, s[36:39], s33 offen offset:1024 sc1
  s_add_u32 s33, s33, 4096
K3_EN:
  s_add_u32 s55, s55, 1
  s_add_u32 s57, s57, 8
  s_cmp_lt_u32 s55, s56
  s_cbranch_scc1 K3_EL
  s_cmp_lt_u32 s55, 7
  s_cbranch_scc1 K3_E
  v_mov_b32 v40, v38
  v_mov_b32 v41, v39
  buffer_store_dwordx4 v[40:43], v26, s[36:39], s34 offen sc1
K3_E:
  s_nop 1
  s_waitcnt vmcnt(0)
  s_barrier
  s_cmp_lg_u32 s3, 0
  s_cbranch_scc1 S3_N
  s_add_u32 s43, s46, 0x1328000
  v_lshl_add_u32 v176, v1, 11, s43
  v_mov_b32 v178, s40
  v_mov_b32 v179, s41
  s_mov_b64 exec, 0x1
  global_store_dwordx2 v176, v[178:179], s[4:5] sc1
  s_mov_b64 exec, -1
S3_N:
  s_mov_b64 s[24:25], s[72:73]
  buffer_load_dwordx4 v[128:131], v3, s[12:15], s53 offen offset:0
  buffer_load_dwordx4 v[132:135], v3, s[12:15], s53 offen offset:1024
  buffer_load_dwordx4 v[136:139], v3, s[12:15], s53 offen offset:2048
  buffer_load_dwordx4 v[140:143], v3, s[12:15], s53 offen offset:3072
  s_add_u32 s53, s53, 32768
  buffer_load_dwordx4 v[144:147], v3, s[12:15], s53 offen offset:0
  buffer_load_dwordx4 v[148:151], v3, s[12:15], s53 offen offset:1024
  buffer_load_dwordx4 v[152:155], v3, s[12:15], s53 offen offset:2048
  buffer_load_dwordx4 v[156:159], v3, s[12:15], s53 offen offset:3072
  s_add_u32 s53, s53, 32768
  buffer_load_dwordx4 v[160:163], v3, s[12:15], s53 offen offset:0
  buffer_load_dwordx4 v[164:167], v3, s[12:15], s53 offen offset:1024
  buffer_load_dwordx4 v[168:171], v3, s[12:15], s53 offen offset:2048
  buffer_load_dwordx4 v[172:175], v3, s[12:15], s53 offen offset:3072
  s_add_u32 s53, s53, 32768
  v_and_b32 v4, 15, v1
  v_lshrrev_b32 v5, 4, v1
  v_add_u32 v8, s54, v3
  s_lshr_b32 s28, s3, 1
  s_and_b32 s29, s3, 1
  s_lshl_b32 s31, s51, 8
  s_lshl_b32 s30, s29, 5
  s_add_u32 s31, s31, s30
  s_add_u32 s31, s31, 0x1312800
  v_lshlrev_b32 v7, 6, v5
  buffer_load_dwordx4 v[12:15], v7, s[36:39], s31 offen
  buffer_load_dwordx4 v[184:187], v7, s[36:39], s31 offen offset:16
  s_lshl_b32 s30, s50, 16
  s_lshl_b32 s31, s28, 14
  s_add_u32 s30, s30, s31
  s_lshl_b32 s31, s51, 7
  s_add_u32 s31, s30, s31
  s_lshl_b32 s32, s29, 4
  s_add_u32 s31, s31, s32
  v_lshl_add_u32 v6, v4, 10, s31
  v_lshl_add_u32 v6, v5, 5, v6
  s_lshl_b32 s31, s51, 11
  s_add_u32 s30, s30, s31
  s_lshl_b32 s31, s29, 9
  s_add_u32 s30, s30, s31
  s_add_u32 s55, s30, 0x400000
  v_lshrrev_b32 v9, 1, v5
  v_lshlrev_b32 v9, 10, v9
  v_lshl_add_u32 v9, v4, 4, v9
  v_and_b32 v10, 1, v5
  v_lshl_add_u32 v9, v10, 3, v9
  s_cmp_lg_u32 s3, 0
  s_cbranch_scc1 S3_W
  s_lshr_b32 s30, s50, 1
  s_lshl_b32 s30, s30, 7
  s_add_u32 s30, s30, 0x1328000
  v_lshl_add_u32 v11, v1, 4, s30
  s_mov_b32 s42, 0
  s_mov_b64 exec, 0xff
S3_P:
  s_sleep 3
  global_load_dwordx4 v[176:179], v11, s[4:5] offset:0 sc1
  s_waitcnt vmcnt(0)
  v_xor_b32 v176, s40, v176
  v_xor_b32 v177, s41, v177
  v_xor_b32 v178, s40, v178
  v_xor_b32 v179, s41, v179
  v_or_b32 v176, v176, v177
  v_or_b32 v176, v176, v178
  v_or_b32 v176, v176, v179
  v_cmp_ne_u32 vcc, 0, v176
  s_add_u32 s42, s42, 1
  s_cmp_gt_u32 s42, 0x40000
  s_cbranch_scc1 S3_P_D
  s_nop 2
  s_cbranch_vccnz S3_P
S3_P_D:
  s_mov_b64 exec, -1
S3_W:
  s_waitcnt vmcnt(0)
  v_mov_b32 v2, v184
  v_mov_b32 v7, v185
  v_mov_b32 v10, v186
  v_mov_b32 v11, v187
  s_barrier
  buffer_load_dwordx4 v[16:19], v3, s[8:11], s52 offen offset:0
  buffer_load_dwordx4 v[20:23], v3, s[8:11], s52 offen offset:1024
  buffer_load_dwordx4 v[24:27], v3, s[8:11], s52 offen offset:2048
  buffer_load_dwordx4 v[28:31], v3, s[8:11], s52 offen offset:3072
  s_add_u32 s52, s52, 32768
  buffer_load_dwordx4 v[32:35], v3, s[8:11], s52 offen offset:0
  buffer_load_dwordx4 v[36:39], v3, s[8:11], s52 offen offset:1024
  buffer_load_dwordx4 v[40:43], v3, s[8:11], s52 offen offset:2048
  buffer_load_dwordx4 v[44:47], v3, s[8:11], s52 offen offset:3072
  s_add_u32 s52, s52, 32768
  buffer_load_dwordx4 v[48:51], v3, s[8:11], s52 offen offset:0
  buffer_load_dwordx4 v[52:55], v3, s[8:11], s52 offen offset:1024
  buffer_load_dwordx4 v[56:59], v3, s[8:11], s52 offen offset:2048
  buffer_load_dwordx4 v[60:63], v3, s[8:11], s52 offen offset:3072
  s_add_u32 s52, s52, 32768
  buffer_load_dwordx4 v[64:67], v3, s[8:11], s52 offen offset:0
  buffer_load_dwordx4 v[68:71], v3, s[8:11], s52 offen offset:1024
  buffer_load_dwordx4 v[72:75], v3, s[8:11], s52 offen offset:2048
  buffer_load_dwordx4 v[76:79], v3, s[8:11], s52 offen offset:3072
  s_add_u32 s52, s52, 32768
  buffer_load_dwordx4 v[80:83], v3, s[8:11], s52 offen offset:0
  buffer_load_dwordx4 v[84:87], v3, s[8:11], s52 offen offset:1024
  buffer_load_dwordx4 v[88:91], v3, s[8:11], s52 offen offset:2048
  buffer_load_dwordx4 v[92:95], v3, s[8:11], s52 offen offset:3072
  s_add_u32 s52, s52, 32768
  buffer_load_dwordx4 v[96:99], v3, s[8:11], s52 offen offset:0
  buffer_load_dwordx4 v[100:103], v3, s[8:11], s52 offen offset:1024
  buffer_load_dwordx4 v[104:107], v3, s[8:11], s52 offen offset:2048
  buffer_load_dwordx4 v[108:111], v3, s[8:11], s52 offen offset:3072
  s_add_u32 s52, s52, 32768
  buffer_load_dwordx4 v[112:115], v3, s[8:11], s52 offen offset:0
  buffer_load_dwordx4 v[116:119], v3, s[8:11], s52 offen offset:1024
  buffer_load_dwordx4 v[120:123], v3, s[8:11], s52 offen offset:2048
  buffer_load_dwordx4 v[124:127], v3, s[8:11], s52 offen offset:3072
  s_add_u32 s52, s52, 32768
  s_waitcnt lgkmcnt(0)
  s_mov_b32 s26, 0x200000
  s_mov_b32 s27, 0x00020000
  ds_read_b128 v[176:179], v8 offset:0
  ds_read_b128 v[180:183], v8 offset:1024
  ds_read_b128 v[184:187], v8 offset:2048
  ds_read_b128 v[188:191], v8 offset:3072
  s_waitcnt vmcnt(24) lgkmcnt(0)
  v_mfma_f32_16x16x32_bf16 v[192:195], v[176:179], v[16:19], 0
  v_mfma_f32_16x16x32_bf16 v[196:199], v[180:183], v[16:19], 0
  v_mfma_f32_16x16x32_bf16 v[200:203], v[184:187], v[16:19], 0
  v_mfma_f32_16x16x32_bf16 v[204:207], v[188:191], v[16:19], 0
  v_mfma_f32_16x16x32_bf16 v[208:211], v[176:179], v[20:23], 0
  v_mfma_f32_16x16x32_bf16 v[212:215], v[180:183], v[20:23], 0
  v_mfma_f32_16x16x32_bf16 v[216:219], v[184:187], v[20:23], 0
  v_mfma_f32_16x16x32_bf16 v[220:223], v[188:191], v[20:23], 0
  v_mfma_f32_16x16x32_bf16 v[224:227], v[176:179], v[24:27], 0
  v_mfma_f32_16x16x32_bf16 v[228:231], v[180:183], v[24:27], 0
  v_mfma_f32_16x16x32_bf16 v[232:235], v[184:187], v[24:27], 0
  v_mfma_f32_16x16x32_bf16 v[236:239], v[188:191], v[24:27], 0
  v_mfma_f32_16x16x32_bf16 v[240:243], v[176:179], v[28:31], 0
  v_mfma_f32_16x16x32_bf16 v[244:247], v[180:183], v[28:31], 0
  v_mfma_f32_16x16x32_bf16 v[248:251], v[184:187], v[28:31], 0
  v_mfma_f32_16x16x32_bf16 v[252:255], v[188:191], v[28:31], 0
  buffer_load_dwordx2 v[16:17], v9, s[36:39], s55 offen offset:0
  buffer_load_dwordx2 v[18:19], v9, s[36:39], s55 offen offset:256
  ds_read_b128 v[176:179], v8 offset:4096
  ds_read_b128 v[180:183], v8 offset:5120
  ds_read_b128 v[184:187], v8 offset:6144
  ds_read_b128 v[188:191], v8 offset:7168
  s_waitcnt vmcnt(22) lgkmcnt(0)
  v_mfma_f32_16x16x32_bf16 v[192:195], v[176:179], v[32:35], v[192:195]
  v_mfma_f32_16x16x32_bf16 v[196:199], v[180:183], v[32:35], v[196:199]
  v_mfma_f32_16x16x32_bf16 v[200:203], v[184:187], v[32:35], v[200:203]
  v_mfma_f32_16x16x32_bf16 v[204:207], v[188:191], v[32:35], v[204:207]
  v_mfma_f32_16x16x32_bf16 v[208:211], v[176:179], v[36:39], v[208:211]
  v_mfma_f32_16x16x32_bf16 v[212:215], v[180:183], v[36:39], v[212:215]
  v_mfma_f32_16x16x32_bf16 v[216:219], v[184:187], v[36:39], v[216:219]
  v_mfma_f32_16x16x32_bf16 v[220:223], v[188:191], v[36:39], v[220:223]
  v_mfma_f32_16x16x32_bf16 v[224:227], v[176:179], v[40:43], v[224:227]
  v_mfma_f32_16x16x32_bf16 v[228:231], v[180:183], v[40:43], v[228:231]
  v_mfma_f32_16x16x32_bf16 v[232:235], v[184:187], v[40:43], v[232:235]
  v_mfma_f32_16x16x32_bf16 v[236:239], v[188:191], v[40:43], v[236:239]
  v_mfma_f32_16x16x32_bf16 v[240:243], v[176:179], v[44:47], v[240:243]
  v_mfma_f32_16x16x32_bf16 v[244:247], v[180:183], v[44:47], v[244:247]
  v_mfma_f32_16x16x32_bf16 v[248:251], v[184:187], v[44:47], v[248:251]
  v_mfma_f32_16x16x32_bf16 v[252:255], v[188:191], v[44:47], v[252:255]
  ds_read_b128 v[176:179], v8 offset:8192
  ds_read_b128 v[180:183], v8 offset:9216
  ds_read_b128 v[184:187], v8 offset:10240
  ds_read_b128 v[188:191], v8 offset:11264
  s_waitcnt vmcnt(18) lgkmcnt(0)
  v_mfma_f32_16x16x32_bf16 v[192:195], v[176:179], v[48:51], v[192:195]
  v_mfma_f32_16x16x32_bf16 v[196:199], v[180:183], v[48:51], v[196:199]
  v_mfma_f32_16x16x32_bf16 v[200:203], v[184:187], v[48:51], v[200:203]
  v_mfma_f32_16x16x32_bf16 v[204:207], v[188:191], v[48:51], v[204:207]
  v_mfma_f32_16x16x32_bf16 v[208:211], v[176:179], v[52:55], v[208:211]
  v_mfma_f32_16x16x32_bf16 v[212:215], v[180:183], v[52:55], v[212:215]
  v_mfma_f32_16x16x32_bf16 v[216:219], v[184:187], v[52:55], v[216:219]
  v_mfma_f32_16x16x32_bf16 v[220:223], v[188:191], v[52:55], v[220:223]
  v_mfma_f32_16x16x32_bf16 v[224:227], v[176:179], v[56:59], v[224:227]
  v_mfma_f32_16x16x32_bf16 v[228:231], v[180:183], v[56:59], v[228:231]
  v_mfma_f32_16x16x32_bf16 v[232:235], v[184:187], v[56:59], v[232:235]
  v_mfma_f32_16x16x32_bf16 v[236:239], v[188:191], v[56:59], v[236:239]
  v_mfma_f32_16x16x32_bf16 v[240:243], v[176:179], v[60:63], v[240:243]
  v_mfma_f32_16x16x32_bf16 v[244:247], v[180:183], v[60:63], v[244:247]
  v_mfma_f32_16x16x32_bf16 v[248:251], v[184:187], v[60:63], v[248:251]
  v_mfma_f32_16x16x32_bf16 v[252:255], v[188:191], v[60:63], v[252:255]
  ds_read_b128 v[176:179], v8 offset:12288
  ds_read_b128 v[180:183], v8 offset:13312
  ds_read_b128 v[184:187], v8 offset:14336
  ds_read_b128 v[188:191], v8 offset:15360
  s_waitcnt vmcnt(14) lgkmcnt(0)
  v_mfma_f32_16x16x32_bf16 v[192:195], v[176:179], v[64:67], v[192:195]
  v_mfma_f32_16x16x32_bf16 v[196:199], v[180:183], v[64:67], v[196:199]
  v_mfma_f32_16x16x32_bf16 v[200:203], v[184:187], v[64:67], v[200:203]
  v_mfma_f32_16x16x32_bf16 v[204:207], v[188:191], v[64:67], v[204:207]
  v_mfma_f32_16x16x32_bf16 v[208:211], v[176:179], v[68:71], v[208:211]
  v_mfma_f32_16x16x32_bf16 v[212:215], v[180:183], v[68:71], v[212:215]
  v_mfma_f32_16x16x32_bf16 v[216:219], v[184:187], v[68:71], v[216:219]
  v_mfma_f32_16x16x32_bf16 v[220:223], v[188:191], v[68:71], v[220:223]
  v_mfma_f32_16x16x32_bf16 v[224:227], v[176:179], v[72:75], v[224:227]
  v_mfma_f32_16x16x32_bf16 v[228:231], v[180:183], v[72:75], v[228:231]
  v_mfma_f32_16x16x32_bf16 v[232:235], v[184:187], v[72:75], v[232:235]
  v_mfma_f32_16x16x32_bf16 v[236:239], v[188:191], v[72:75], v[236:239]
  v_mfma_f32_16x16x32_bf16 v[240:243], v[176:179], v[76:79], v[240:243]
  v_mfma_f32_16x16x32_bf16 v[244:247], v[180:183], v[76:79], v[244:247]
  v_mfma_f32_16x16x32_bf16 v[248:251], v[184:187], v[76:79], v[248:251]
  v_mfma_f32_16x16x32_bf16 v[252:255], v[188:191], v[76:79], v[252:255]
  s_waitcnt vmcnt(10) lgkmcnt(0)
  v_mfma_f32_16x16x32_bf16 v[192:195], v[128:131], v[80:83], v[192:195]
  v_mfma_f32_16x16x32_bf16 v[196:199], v[132:135], v[80:83], v[196:199]
  v_mfma_f32_16x16x32_bf16 v[200:203], v[136:139], v[80:83], v[200:203]
  v_mfma_f32_16x16x32_bf16 v[204:207], v[140:143], v[80:83], v[204:207]
  v_mfma_f32_16x16x32_bf16 v[208:211], v[128:131], v[84:87], v[208:211]
  v_mfma_f32_16x16x32_bf16 v[212:215], v[132:135], v[84:87], v[212:215]
  v_mfma_f32_16x16x32_bf16 v[216:219], v[136:139], v[84:87], v[216:219]
  v_mfma_f32_16x16x32_bf16 v[220:223], v[140:143], v[84:87], v[220:223]
  v_mfma_f32_16x16x32_bf16 v[224:227], v[128:131], v[88:91], v[224:227]
  v_mfma_f32_16x16x32_bf16 v[228:231], v[132:135], v[88:91], v[228:231]
  v_mfma_f32_16x16x32_bf16 v[232:235], v[136:139], v[88:91], v[232:235]
  v_mfma_f32_16x16x32_bf16 v[236:239], v[140:143], v[88:91], v[236:239]
  v_mfma_f32_16x16x32_bf16 v[240:243], v[128:131], v[92:95], v[240:243]
  v_mfma_f32_16x16x32_bf16 v[244:247], v[132:135], v[92:95], v[244:247]
  v_mfma_f32_16x16x32_bf16 v[248:251], v[136:139], v[92:95], v[248:251]
  v_mfma_f32_16x16x32_bf16 v[252:255], v[140:143], v[92:95], v[252:255]
  s_waitcnt vmcnt(6) lgkmcnt(0)
  v_mfma_f32_16x16x32_bf16 v[192:195], v[144:147], v[96:99], v[192:195]
  v_mfma_f32_16x16x32_bf16 v[196:199], v[148:151], v[96:99], v[196:199]
  v_mfma_f32_16x16x32_bf16 v[200:203], v[152:155], v[96:99], v[200:203]
  v_mfma_f32_16x16x32_bf16 v[204:207], v[156:159], v[96:99], v[204:207]
  v_mfma_f32_16x16x32_bf16 v[208:211], v[144:147], v[100:103], v[208:211]
  v_mfma_f32_16x16x32_bf16 v[212:215], v[148:151], v[100:103], v[212:215]
  v_mfma_f32_16x16x32_bf16 v[216:219], v[152:155], v[100:103], v[216:219]
  v_mfma_f32_16x16x32_bf16 v[220:223], v[156:159], v[100:103], v[220:223]
  v_mfma_f32_16x16x32_bf16 v[224:227], v[144:147], v[104:107], v[224:227]
  v_mfma_f32_16x16x32_bf16 v[228:231], v[148:151], v[104:107], v[228:231]
  v_mfma_f32_16x16x32_bf16 v[232:235], v[152:155], v[104:107], v[232:235]
  v_mfma_f32_16x16x32_bf16 v[236:239], v[156:159], v[104:107], v[236:239]
  v_mfma_f32_16x16x32_bf16 v[240:243], v[144:147], v[108:111], v[240:243]
  v_mfma_f32_16x16x32_bf16 v[244:247], v[148:151], v[108:111], v[244:247]
  v_mfma_f32_16x16x32_bf16 v[248:251], v[152:155], v[108:111], v[248:251]
  v_mfma_f32_16x16x32_bf16 v[252:255], v[156:159], v[108:111], v[252:255]
  s_waitcnt vmcnt(2) lgkmcnt(0)
  v_swap_b32 v114, v116
  v_swap_b32 v115, v117
  v_swap_b32 v122, v124
  v_swap_b32 v123, v125
  v_mfma_f32_16x16x32_bf16 v[192:195], v[160:163], v[112:115], v[192:195]
  v_mfma_f32_16x16x32_bf16 v[196:199], v[164:167], v[112:115], v[196:199]
  v_mfma_f32_16x16x32_bf16 v[200:203], v[168:171], v[112:115], v[200:203]
  v_mfma_f32_16x16x32_bf16 v[204:207], v[172:175], v[112:115], v[204:207]
  v_mfma_f32_16x16x32_bf16 v[208:211], v[160:163], v[116:119], v[208:211]
  v_mfma_f32_16x16x32_bf16 v[212:215], v[164:167], v[116:119], v[212:215]
  v_mfma_f32_16x16x32_bf16 v[216:219], v[168:171], v[116:119], v[216:219]
  v_mfma_f32_16x16x32_bf16 v[220:223], v[172:175], v[116:119], v[220:223]
  v_mfma_f32_16x16x32_bf16 v[224:227], v[160:163], v[120:123], v[224:227]
  v_mfma_f32_16x16x32_bf16 v[228:231], v[164:167], v[120:123], v[228:231]
  v_mfma_f32_16x16x32_bf16 v[232:235], v[168:171], v[120:123], v[232:235]
  v_mfma_f32_16x16x32_bf16 v[236:239], v[172:175], v[120:123], v[236:239]
  v_mfma_f32_16x16x32_bf16 v[240:243], v[160:163], v[124:127], v[240:243]
  v_mfma_f32_16x16x32_bf16 v[244:247], v[164:167], v[124:127], v[244:247]
  v_mfma_f32_16x16x32_bf16 v[248:251], v[168:171], v[124:127], v[248:251]
  v_mfma_f32_16x16x32_bf16 v[252:255], v[172:175], v[124:127], v[252:255]
  ds_write_b128 v8, v[192:195] offset:0
  ds_write_b128 v8, v[196:199] offset:1024
  ds_write_b128 v8, v[200:203] offset:2048
  ds_write_b128 v8, v[204:207] offset:3072
  ds_write_b128 v8, v[208:211] offset:4096
  ds_write_b128 v8, v[212:215] offset:5120
  ds_write_b128 v8, v[216:219] offset:6144
  ds_write_b128 v8, v[220:223] offset:7168
  ds_write_b128 v8, v[224:227] offset:8192
  ds_write_b128 v8, v[228:231] offset:9216
  ds_write_b128 v8, v[232:235] offset:10240
  ds_write_b128 v8, v[236:239] offset:11264
  ds_write_b128 v8, v[240:243] offset:12288
  ds_write_b128 v8, v[244:247] offset:13312
  ds_write_b128 v8, v[248:251] offset:14336
  ds_write_b128 v8, v[252:255] offset:15360
  s_lshl_b32 s31, s3, 11
  s_add_u32 s31, s31, 3072
  v_add_u32 v8, s31, v3
  v_add_u32 v9, 0x10000, v8
  s_waitcnt lgkmcnt(0)
  s_barrier
  ds_read_b128 v[32:35], v8 offset:0
  ds_read_b128 v[36:39], v8 offset:1024
  ds_read_b128 v[40:43], v8 offset:16384
  ds_read_b128 v[44:47], v8 offset:17408
  ds_read_b128 v[48:51], v8 offset:32768
  ds_read_b128 v[52:55], v8 offset:33792
  ds_read_b128 v[56:59], v8 offset:49152
  ds_read_b128 v[60:63], v8 offset:50176
  s_waitcnt lgkmcnt(0)
  ds_read_b128 v[64:67], v9 offset:0
  ds_read_b128 v[68:71], v9 offset:1024
  ds_read_b128 v[72:75], v9 offset:16384
  ds_read_b128 v[76:79], v9 offset:17408
  ds_read_b128 v[80:83], v9 offset:32768
  ds_read_b128 v[84:87], v9 offset:33792
  ds_read_b128 v[88:91], v9 offset:49152
  ds_read_b128 v[92:95], v9 offset:50176
  v_add_f32 v32, v32, v40
  v_add_f32 v48, v48, v56
  v_add_f32 v32, v32, v48
  v_add_f32 v33, v33, v41
  v_add_f32 v49, v49, v57
  v_add_f32 v33, v33, v49
  v_add_f32 v34, v34, v42
  v_add_f32 v50, v50, v58
  v_add_f32 v34, v34, v50
  v_add_f32 v35, v35, v43
  v_add_f32 v51, v51, v59
  v_add_f32 v35, v35, v51
  v_add_f32 v36, v36, v44
  v_add_f32 v52, v52, v60
  v_add_f32 v36, v36, v52
  v_add_f32 v37, v37, v45
  v_add_f32 v53, v53, v61
  v_add_f32 v37, v37, v53
  v_add_f32 v38, v38, v46
  v_add_f32 v54, v54, v62
  v_add_f32 v38, v38, v54
  v_add_f32 v39, v39, v47
  v_add_f32 v55, v55, v63
  v_add_f32 v39, v39, v55
  s_waitcnt lgkmcnt(0)
  v_add_f32 v64, v64, v72
  v_add_f32 v80, v80, v88
  v_add_f32 v32, v32, v64
  v_add_f32 v32, v32, v80
  v_add_f32 v65, v65, v73
  v_add_f32 v81, v81, v89
  v_add_f32 v33, v33, v65
  v_add_f32 v33, v33, v81
  v_add_f32 v66, v66, v74
  v_add_f32 v82, v82, v90
  v_add_f32 v34, v34, v66
  v_add_f32 v34, v34, v82
  v_add_f32 v67, v67, v75
  v_add_f32 v83, v83, v91
  v_add_f32 v35, v35, v67
  v_add_f32 v35, v35, v83
  v_add_f32 v68, v68, v76
  v_add_f32 v84, v84, v92
  v_add_f32 v36, v36, v68
  v_add_f32 v36, v36, v84
  v_add_f32 v69, v69, v77
  v_add_f32 v85, v85, v93
  v_add_f32 v37, v37, v69
  v_add_f32 v37, v37, v85
  v_add_f32 v70, v70, v78
  v_add_f32 v86, v86, v94
  v_add_f32 v38, v38, v70
  v_add_f32 v38, v38, v86
  v_add_f32 v71, v71, v79
  v_add_f32 v87, v87, v95
  v_add_f32 v39, v39, v71
  v_add_f32 v39, v39, v87
  s_waitcnt vmcnt(0)
  v_lshlrev_b32 v20, 16, v16
  v_and_b32 v21, 0xffff0000, v16
  v_fmac_f32 v20, v32, v12
  v_fmac_f32 v21, v33, v13
  v_cvt_pk_bf16_f32 v24, v20, v21
  v_lshlrev_b32 v20, 16, v17
  v_and_b32 v21, 0xffff0000, v17
  v_fmac_f32 v20, v34, v14
  v_fmac_f32 v21, v35, v15
  v_cvt_pk_bf16_f32 v25, v20, v21
  v_lshlrev_b32 v20, 16, v18
  v_and_b32 v21, 0xffff0000, v18
  v_fmac_f32 v20, v36, v2
  v_fmac_f32 v21, v37, v7
  v_cvt_pk_bf16_f32 v26, v20, v21
  v_lshlrev_b32 v20, 16, v19
  v_and_b32 v21, 0xffff0000, v19
  v_fmac_f32 v20, v38, v10
  v_fmac_f32 v21, v39, v11
  v_cvt_pk_bf16_f32 v27, v20, v21
  buffer_store_dwordx4 v[24:27], v6, s[24:27], 0 offen
F_END:
  s_endpgm
.section .rodata,"a"
.p2align 6
.amdhsa_kernel adaLN_cond__ssm_conv_s4__glu_gated_swiglu__prompt_kernel
  .amdhsa_next_free_vgpr 256
  .amdhsa_next_free_sgpr 80
  .amdhsa_accum_offset 256
  .amdhsa_group_segment_fixed_size 0
  .amdhsa_kernarg_size 144
  .amdhsa_user_sgpr_count 2
  .amdhsa_user_sgpr_kernarg_segment_ptr 1
  .amdhsa_system_sgpr_workgroup_id_x 1
.end_amdhsa_kernel
```
